```python
import torch

def _softmax(x, axis=-1):
    return torch.softmax(x, dim=axis)
def _gelu(x):
    return torch.nn.functional.gelu(x, approximate="tanh")
def _silu(x):
    return torch.nn.functional.silu(x)
def _sigmoid(x):
    return torch.sigmoid(x)
def _layernorm(x, axis=-1, eps=1e-5):
    m = x.mean(dim=axis, keepdim=True)
    v = x.var(dim=axis, keepdim=True, unbiased=False)
    return (x - m) / torch.sqrt(v + eps)
def _scatter_add(tgt, idx, src, axis=0):
    return tgt.clone().index_add_(axis, idx, src)
def _segment_sum(src, seg, n):
    out = torch.zeros((n,) + src.shape[1:], dtype=src.dtype)
    return out.index_add_(0, seg, src)
def _pad(x, pw):
    flat = tuple(v for pair in reversed(pw) for v in pair)
    return torch.nn.functional.pad(x, flat)

kernel_name = 'interleave_layers__sliding_local_dilated__dense_activation_gelu__prompt'

def setup_inputs():

    _w = (lambda a: (lambda t: t.to(torch.bfloat16) if t.is_floating_point() else t)(torch.as_tensor(a)))
    def _A_setup():
        B, S, D = 1, 2048, 576
        return {
            "x": _w((lambda *s: torch.randn(*s, dtype=torch.bfloat16) * 0.05)(B, S, D)),
            "wqkv": _w((lambda *s: torch.randn(*s, dtype=torch.bfloat16) * 0.05)(D, 3 * D)),
            "wo": _w((lambda *s: torch.randn(*s, dtype=torch.bfloat16) * 0.05)(D, D)),
        }
    _A_in = _A_setup()

    def _B_setup():
        B, S, D, F = 1, 2048, 576, 4608
        return {
            "x": _w((lambda *s: torch.randn(*s, dtype=torch.bfloat16) * 0.05)(B, S, D)),
            "w1": _w((lambda *s: torch.randn(*s, dtype=torch.bfloat16) * 0.8)(D, F) * (D ** -0.5)),
            "b1": _w((lambda *s: torch.randn(*s, dtype=torch.bfloat16) * 0.8)(F) * 0.01),
            "w2": _w((lambda *s: torch.randn(*s, dtype=torch.bfloat16) * 0.8)(F, D) * (F ** -0.5)),
            "b2": _w((lambda *s: torch.randn(*s, dtype=torch.bfloat16) * 0.8)(D) * 0.01),
        }
    _B_in = _B_setup()

    return {
        "A_x": _A_in["x"],
        "A_wqkv": _A_in["wqkv"],
        "A_wo": _A_in["wo"],
        "B_x": _B_in["x"],
        "B_w1": _B_in["w1"],
        "B_b1": _B_in["b1"],
        "B_w2": _B_in["w2"],
        "B_b2": _B_in["b2"],
    }

def reference(A_x, A_wqkv, A_wo, B_x, B_w1, B_b1, B_w2, B_b2):
    def _A_ref(x, wqkv, wo):
        B, S, D = x.shape
        H = 32; Dh = D // H
        W, dil = 8, 2
        qkv = (lambda x, *d: x.permute(*d))((x @ wqkv).reshape(B, S, 3, H, Dh), 2, 0, 3, 1, 4)
        q, k, v = qkv[0], qkv[1], qkv[2]
        scale = Dh ** -0.5
        pos = torch.arange(S)
        off = torch.arange(W) * dil
        idx = pos[:, None] - off[None, :]
        mask = idx >= 0
        idx_c = torch.where(mask, idx, 0).reshape(-1)
        kg = k[:, :, idx_c, :].reshape(B, H, S, W, Dh)
        vg = v[:, :, idx_c, :].reshape(B, H, S, W, Dh)
        logits = torch.einsum("bhsd,bhswd->bhsw", q, kg) * scale
        logits = torch.where(mask[None, None, :, :], logits, -1e9)
        attn = _softmax(logits, axis=-1)
        o = torch.einsum("bhsw,bhswd->bhsd", attn, vg)
        return (lambda x, *d: x.permute(*d))(o, 0, 2, 1, 3).reshape(B, S, D) @ wo

    def _B_ref(x, w1, b1, w2, b2):
        h = torch.einsum("bsd,df->bsf", x, w1) + b1
        h = _gelu(h)
        return torch.einsum("bsf,fd->bsd", h, w2) + b2

    x = A_x
    x = x + _A_ref(_layernorm(x, axis=-1), A_wqkv, A_wo)
    x = x + _B_ref(_layernorm(x, axis=-1), B_w1, B_b1, B_w2, B_b2)
    x = x + _A_ref(_layernorm(x, axis=-1), A_wqkv, A_wo)
    x = x + _B_ref(_layernorm(x, axis=-1), B_w1, B_b1, B_w2, B_b2)
    return x
```

```asm
; @launch grid=(256,1,1) block=(768,1,1) lds=163840
.amdgcn_target "amdgcn-amd-amdhsa--gfx950"
.text
.globl interleave_layers__sliding_local_dilated__dense_activation_gelu__prompt_kernel
.p2align 8
.type interleave_layers__sliding_local_dilated__dense_activation_gelu__prompt_kernel,@function
interleave_layers__sliding_local_dilated__dense_activation_gelu__prompt_kernel:
  s_cmp_ge_u32 s2, 256
  s_cbranch_scc1 L_interleave_layers__sliding_local_dilated__dense_activation_gelu__prompt_kernel_exit
  s_load_dwordx2 s[22:23], s[0:1], 0
  s_load_dwordx4 s[24:27], s[0:1], 8
  s_load_dwordx4 s[28:31], s[0:1], 32
  s_load_dwordx2 s[32:33], s[0:1], 48
  s_load_dwordx4 s[4:7], s[0:1], 56
  s_load_dwordx4 s[40:43], s[0:1], 72
  s_memrealtime s[44:45]
  v_lshrrev_b32 v1, 6, v0
  s_nop 0
  v_readfirstlane_b32 s3, v1
  v_and_b32 v1, 63, v0
  v_lshlrev_b32 v2, 4, v1
  v_lshrrev_b32 v3, 4, v1
  v_and_b32 v4, 15, v1
  s_cmp_lg_u32 s3, 0
  s_cbranch_scc1 L_M_nz
  v_lshlrev_b32 v5, 3, v1
  v_add_u32 v5, 163328, v5
  v_mov_b32 v6, 0
  v_mov_b32 v7, 0
  ds_write_b64 v5, v[6:7]
L_M_nz:
  s_waitcnt lgkmcnt(0)
  s_mov_b32 s8, s42
  s_mov_b32 s9, s43
  s_mov_b32 s10, 0x5000000
  s_mov_b32 s11, 0x20000
  s_mov_b32 s12, s30
  s_mov_b32 s13, s31
  s_mov_b32 s14, 0x2400
  s_mov_b32 s15, 0x20000
  s_mov_b32 s16, s6
  s_mov_b32 s17, s7
  s_mov_b32 s18, 0x240000
  s_mov_b32 s19, 0x20000
  s_mov_b64 s[20:21], s[4:5]
  s_mov_b64 s[34:35], s[40:41]
  s_or_b32 s36, s2, s3
  s_cmp_lg_u32 s36, 0
  s_cbranch_scc1 L_M_nt
  s_lshl_b32 s46, s45, 2
  s_lshr_b32 s47, s44, 31
  s_lshl_b32 s47, s47, 1
  s_or_b32 s46, s46, s47
  s_or_b32 s46, s46, 1
  s_lshl_b32 s47, s44, 1
  s_or_b32 s47, s47, 1
  v_mov_b32 v6, s47
  v_mov_b32 v7, s46
  v_mov_b32 v5, 0
  s_mov_b64 exec, 1
  global_store_dwordx2 v5, v[6:7], s[34:35] sc1
  s_mov_b64 exec, -1
L_M_nt:
  s_barrier
  v_bfe_u32 v46, v1, 2, 2
  v_and_b32 v47, 3, v1
  s_cmp_ge_u32 s3, 6
  s_cselect_b32 s56, 1, 0
  s_add_u32 s36, s2, 64
  s_cmp_lt_u32 s2, 120
  s_cselect_b32 s36, s2, s36
  s_add_u32 s37, s2, 216
  s_cmp_lt_u32 s2, 104
  s_cselect_b32 s37, 999, s37
  s_add_u32 s38, s2, 120
  s_cmp_lt_u32 s2, 64
  s_cselect_b32 s37, s38, s37
  s_cmp_eq_u32 s56, 0
  s_cselect_b32 s51, s36, s37
  s_mul_i32 s50, s56, 36864
  s_mul_i32 s49, s56, 6
  s_sub_u32 s49, s3, s49
  s_and_b32 s45, s51, 7
  s_lshr_b32 s46, s51, 3
  s_cmp_ge_u32 s51, 472
  s_cbranch_scc1 L_P_done
  s_and_b32 s36, s51, 0xfffe
  s_cmp_eq_u32 s36, 54
  s_cbranch_scc1 L_P_done
  s_lshl_b32 s37, s49, 10
  s_add_u32 s37, s37, s50
  s_cmp_lt_u32 s51, 56
  s_cbranch_scc1 L_Pi_wq
  s_cmp_lt_u32 s51, 120
  s_cbranch_scc1 L_Pi_x0
  s_cmp_lt_u32 s51, 184
  s_cbranch_scc1 L_Pi_wo
  s_cmp_lt_u32 s51, 328
  s_cbranch_scc1 L_Pi_w1
  s_branch L_Pi_w2
L_Pi_wq:
  s_mov_b32 s52, s24
  s_mov_b32 s53, s25
  s_mov_b32 s54, 0x1e6000
  s_mov_b32 s55, 0x20000
  s_mul_i32 s46, s51, 86
  s_lshr_b32 s46, s46, 8
  s_mul_i32 s45, s46, 3
  s_sub_u32 s45, s51, s45
  s_mul_i32 s40, s46, 110592
  s_mul_i32 s36, s45, 1152
  s_add_u32 s40, s40, s36
  s_lshl_b32 s36, s49, 6
  v_add_u32 v6, s36, v1
  s_mov_b32 s38, 1821
  v_mul_u32_u24 v7, s38, v6
  v_lshrrev_b32 v7, 17, v7
  v_mul_u32_u24 v8, 0x48, v7
  v_sub_u32 v8, v6, v8
  s_mov_b32 s38, 3456
  v_mul_u32_u24 v7, s38, v7
  v_lshl_add_u32 v7, v8, 4, v7
  s_add_u32 m0, s37, 0
  s_nop 0
  buffer_load_dwordx4 v7, s[52:55], s40 offen nt lds
  v_add_u32 v6, s36, v1
  v_add_u32 v6, 384, v6
  s_mov_b32 s38, 1821
  v_mul_u32_u24 v7, s38, v6
  v_lshrrev_b32 v7, 17, v7
  v_mul_u32_u24 v8, 0x48, v7
  v_sub_u32 v8, v6, v8
  s_mov_b32 s38, 3456
  v_mul_u32_u24 v7, s38, v7
  v_lshl_add_u32 v7, v8, 4, v7
  s_add_u32 m0, s37, 6144
  s_nop 0
  buffer_load_dwordx4 v7, s[52:55], s40 offen nt lds
  v_add_u32 v6, s36, v1
  v_add_u32 v6, 768, v6
  s_mov_b32 s38, 1821
  v_mul_u32_u24 v7, s38, v6
  v_lshrrev_b32 v7, 17, v7
  v_mul_u32_u24 v8, 0x48, v7
  v_sub_u32 v8, v6, v8
  s_mov_b32 s38, 3456
  v_mul_u32_u24 v7, s38, v7
  v_lshl_add_u32 v7, v8, 4, v7
  s_add_u32 m0, s37, 12288
  s_nop 0
  buffer_load_dwordx4 v7, s[52:55], s40 offen nt lds
  v_add_u32 v6, s36, v1
  v_add_u32 v6, 1152, v6
  s_mov_b32 s38, 1821
  v_mul_u32_u24 v7, s38, v6
  v_lshrrev_b32 v7, 17, v7
  v_mul_u32_u24 v8, 0x48, v7
  v_sub_u32 v8, v6, v8
  s_mov_b32 s38, 3456
  v_mul_u32_u24 v7, s38, v7
  v_lshl_add_u32 v7, v8, 4, v7
  s_add_u32 m0, s37, 18432
  s_nop 0
  buffer_load_dwordx4 v7, s[52:55], s40 offen nt lds
  v_add_u32 v6, s36, v1
  v_add_u32 v6, 1536, v6
  s_mov_b32 s38, 1821
  v_mul_u32_u24 v7, s38, v6
  v_lshrrev_b32 v7, 17, v7
  v_mul_u32_u24 v8, 0x48, v7
  v_sub_u32 v8, v6, v8
  s_mov_b32 s38, 3456
  v_mul_u32_u24 v7, s38, v7
  v_lshl_add_u32 v7, v8, 4, v7
  s_add_u32 m0, s37, 24576
  s_nop 0
  buffer_load_dwordx4 v7, s[52:55], s40 offen nt lds
  v_add_u32 v6, s36, v1
  v_add_u32 v6, 1920, v6
  s_mov_b32 s38, 1821
  v_mul_u32_u24 v7, s38, v6
  v_lshrrev_b32 v7, 17, v7
  v_mul_u32_u24 v8, 0x48, v7
  v_sub_u32 v8, v6, v8
  s_mov_b32 s38, 3456
  v_mul_u32_u24 v7, s38, v7
  v_lshl_add_u32 v7, v8, 4, v7
  s_add_u32 m0, s37, 30720
  s_nop 0
  buffer_load_dwordx4 v7, s[52:55], s40 offen nt lds
  s_branch L_P_wait
L_Pi_x0:
  s_mov_b32 s52, s22
  s_mov_b32 s53, s23
  s_mov_b32 s54, 0x240000
  s_mov_b32 s55, 0x20000
  s_sub_u32 s46, s46, 7
  s_lshl_b32 s45, s45, 3
  s_add_u32 s46, s46, s45
  s_mul_i32 s40, s46, 36864
  s_lshl_b32 s36, s49, 10
  s_add_u32 s40, s40, s36
  s_add_u32 m0, s37, 0
  s_nop 0
  buffer_load_dwordx4 v2, s[52:55], s40 offen nt lds
  s_add_u32 s40, s40, 6144
  s_add_u32 m0, s37, 6144
  s_nop 0
  buffer_load_dwordx4 v2, s[52:55], s40 offen nt lds
  s_add_u32 s40, s40, 6144
  s_add_u32 m0, s37, 12288
  s_nop 0
  buffer_load_dwordx4 v2, s[52:55], s40 offen nt lds
  s_add_u32 s40, s40, 6144
  s_add_u32 m0, s37, 18432
  s_nop 0
  buffer_load_dwordx4 v2, s[52:55], s40 offen nt lds
  s_add_u32 s40, s40, 6144
  s_add_u32 m0, s37, 24576
  s_nop 0
  buffer_load_dwordx4 v2, s[52:55], s40 offen nt lds
  s_add_u32 s40, s40, 6144
  s_add_u32 m0, s37, 30720
  s_nop 0
  buffer_load_dwordx4 v2, s[52:55], s40 offen nt lds
  s_branch L_P_wait
L_Pi_wo:
  s_mov_b32 s52, s26
  s_mov_b32 s53, s27
  s_mov_b32 s54, 0xa2000
  s_mov_b32 s55, 0x20000
  s_sub_u32 s46, s46, 15
  s_mul_i32 s40, s46, 82944
  s_mul_i32 s36, s45, 144
  s_add_u32 s40, s40, s36
  s_lshl_b32 s36, s49, 6
  v_add_u32 v6, s36, v1
  s_mov_b32 s38, 911
  v_mul_u32_u24 v7, s38, v6
  v_lshrrev_b32 v7, 13, v7
  v_mul_u32_u24 v8, 9, v7
  v_sub_u32 v8, v6, v8
  s_mov_b32 s38, 1152
  v_mul_u32_u24 v7, s38, v7
  v_lshl_add_u32 v7, v8, 4, v7
  s_add_u32 m0, s37, 0
  s_nop 0
  buffer_load_dwordx4 v7, s[52:55], s40 offen nt lds
  v_add_u32 v6, s36, v1
  v_add_u32 v6, 384, v6
  s_mov_b32 s38, 911
  v_mul_u32_u24 v7, s38, v6
  v_lshrrev_b32 v7, 13, v7
  v_mul_u32_u24 v8, 9, v7
  v_sub_u32 v8, v6, v8
  s_mov_b32 s38, 1152
  v_mul_u32_u24 v7, s38, v7
  v_lshl_add_u32 v7, v8, 4, v7
  s_add_u32 m0, s37, 6144
  s_nop 0
  buffer_load_dwordx4 v7, s[52:55], s40 offen nt lds
  s_branch L_P_wait
L_Pi_w1:
  s_mov_b32 s52, s28
  s_mov_b32 s53, s29
  s_mov_b32 s54, 0x510000
  s_mov_b32 s55, 0x20000
  s_sub_u32 s46, s46, 23
  s_mul_i32 s40, s46, 294912
  s_mul_i32 s36, s45, 1152
  s_add_u32 s40, s40, s36
  s_lshl_b32 s36, s49, 6
  v_add_u32 v6, s36, v1
  s_mov_b32 s38, 1821
  v_mul_u32_u24 v7, s38, v6
  v_lshrrev_b32 v7, 17, v7
  v_mul_u32_u24 v8, 0x48, v7
  v_sub_u32 v8, v6, v8
  s_mov_b32 s38, 9216
  v_mul_u32_u24 v7, s38, v7
  v_lshl_add_u32 v7, v8, 4, v7
  s_add_u32 m0, s37, 0
  s_nop 0
  buffer_load_dwordx4 v7, s[52:55], s40 offen nt lds
  v_add_u32 v6, s36, v1
  v_add_u32 v6, 384, v6
  s_mov_b32 s38, 1821
  v_mul_u32_u24 v7, s38, v6
  v_lshrrev_b32 v7, 17, v7
  v_mul_u32_u24 v8, 0x48, v7
  v_sub_u32 v8, v6, v8
  s_mov_b32 s38, 9216
  v_mul_u32_u24 v7, s38, v7
  v_lshl_add_u32 v7, v8, 4, v7
  s_add_u32 m0, s37, 6144
  s_nop 0
  buffer_load_dwordx4 v7, s[52:55], s40 offen nt lds
  v_add_u32 v6, s36, v1
  v_add_u32 v6, 768, v6
  s_mov_b32 s38, 1821
  v_mul_u32_u24 v7, s38, v6
  v_lshrrev_b32 v7, 17, v7
  v_mul_u32_u24 v8, 0x48, v7
  v_sub_u32 v8, v6, v8
  s_mov_b32 s38, 9216
  v_mul_u32_u24 v7, s38, v7
  v_lshl_add_u32 v7, v8, 4, v7
  s_add_u32 m0, s37, 12288
  s_nop 0
  buffer_load_dwordx4 v7, s[52:55], s40 offen nt lds
  v_add_u32 v6, s36, v1
  v_add_u32 v6, 1152, v6
  s_mov_b32 s38, 1821
  v_mul_u32_u24 v7, s38, v6
  v_lshrrev_b32 v7, 17, v7
  v_mul_u32_u24 v8, 0x48, v7
  v_sub_u32 v8, v6, v8
  s_mov_b32 s38, 9216
  v_mul_u32_u24 v7, s38, v7
  v_lshl_add_u32 v7, v8, 4, v7
  s_add_u32 m0, s37, 18432
  s_nop 0
  buffer_load_dwordx4 v7, s[52:55], s40 offen nt lds
  v_add_u32 v6, s36, v1
  v_add_u32 v6, 1536, v6
  s_mov_b32 s38, 1821
  v_mul_u32_u24 v7, s38, v6
  v_lshrrev_b32 v7, 17, v7
  v_mul_u32_u24 v8, 0x48, v7
  v_sub_u32 v8, v6, v8
  s_mov_b32 s38, 9216
  v_mul_u32_u24 v7, s38, v7
  v_lshl_add_u32 v7, v8, 4, v7
  s_add_u32 m0, s37, 24576
  s_nop 0
  buffer_load_dwordx4 v7, s[52:55], s40 offen nt lds
  v_add_u32 v6, s36, v1
  v_add_u32 v6, 1920, v6
  s_mov_b32 s38, 1821
  v_mul_u32_u24 v7, s38, v6
  v_lshrrev_b32 v7, 17, v7
  v_mul_u32_u24 v8, 0x48, v7
  v_sub_u32 v8, v6, v8
  s_mov_b32 s38, 9216
  v_mul_u32_u24 v7, s38, v7
  v_lshl_add_u32 v7, v8, 4, v7
  s_add_u32 m0, s37, 30720
  s_nop 0
  buffer_load_dwordx4 v7, s[52:55], s40 offen nt lds
  s_branch L_P_wait
L_Pi_w2:
  s_mov_b32 s52, s32
  s_mov_b32 s53, s33
  s_mov_b32 s54, 0x510000
  s_mov_b32 s55, 0x20000
  s_sub_u32 s46, s46, 41
  s_mul_i32 s40, s45, 18
  s_add_u32 s40, s40, s46
  s_mul_i32 s40, s40, 36864
  s_lshl_b32 s36, s49, 10
  s_add_u32 s40, s40, s36
  s_add_u32 m0, s37, 0
  s_nop 0
  buffer_load_dwordx4 v2, s[52:55], s40 offen nt lds
  s_add_u32 s40, s40, 6144
  s_add_u32 m0, s37, 6144
  s_nop 0
  buffer_load_dwordx4 v2, s[52:55], s40 offen nt lds
  s_add_u32 s40, s40, 6144
  s_add_u32 m0, s37, 12288
  s_nop 0
  buffer_load_dwordx4 v2, s[52:55], s40 offen nt lds
  s_add_u32 s40, s40, 6144
  s_add_u32 m0, s37, 18432
  s_nop 0
  buffer_load_dwordx4 v2, s[52:55], s40 offen nt lds
  s_add_u32 s40, s40, 6144
  s_add_u32 m0, s37, 24576
  s_nop 0
  buffer_load_dwordx4 v2, s[52:55], s40 offen nt lds
  s_add_u32 s40, s40, 6144
  s_add_u32 m0, s37, 30720
  s_nop 0
  buffer_load_dwordx4 v2, s[52:55], s40 offen nt lds
L_P_wait:
  v_mov_b32 v40, 0x3f803f80
  v_mov_b32 v41, 0x3f803f80
  v_mov_b32 v42, 0x3f803f80
  v_mov_b32 v43, 0x3f803f80
  s_lshl_b32 s36, s56, 2
  s_add_u32 s36, s36, 163584
  v_mov_b32 v8, s36
  v_mov_b32 v9, 1
  s_waitcnt vmcnt(0)
  s_mov_b64 exec, 1
  ds_add_u32 v8, v9
  s_mov_b64 exec, -1
L_P_spin:
  ds_read_b32 v9, v8
  s_waitcnt lgkmcnt(0)
  v_readfirstlane_b32 s36, v9
  s_nop 3
  s_cmp_ge_u32 s36, 6
  s_cbranch_scc1 L_P_go
  s_sleep 2
  s_branch L_P_spin
L_P_go:
  s_lshl_b32 s39, s3, 10
  s_add_u32 s39, s39, 73728
  s_lshl_b32 s48, s49, 1
L_P_vw:
  s_cmp_lt_u32 s51, 56
  s_cbranch_scc1 L_Pp_wq
  s_cmp_lt_u32 s51, 120
  s_cbranch_scc1 L_Pp_x0
  s_cmp_lt_u32 s51, 184
  s_cbranch_scc1 L_Pp_wo
  s_cmp_lt_u32 s51, 328
  s_cbranch_scc1 L_Pp_w1
  s_branch L_Pp_w2
L_Pp_w1:
  s_lshr_b32 s40, s48, 1
  s_and_b32 s41, s48, 1
  s_mul_i32 s40, s40, 96
  s_lshl_b32 s42, s41, 5
  s_add_u32 s42, s42, s40
  s_lshl_b32 s43, s41, 4
  s_add_u32 s43, s43, s40
  s_add_u32 s43, s43, 64
  v_lshl_add_u32 v7, v3, 3, v46
  s_movk_i32 s38, 1152
  v_mul_u32_u24 v7, s38, v7
  v_add_u32 v7, s50, v7
  s_lshl_b32 s44, s42, 1
  v_lshl_add_u32 v6, v47, 4, v7
  v_add_u32 v6, s44, v6
  s_lshl_b32 s44, s43, 1
  v_lshl_add_u32 v10, v47, 3, v7
  v_add_u32 v10, s44, v10
  v_add_u32 v9, 4608, v6
  v_add_u32 v11, 4608, v10
  ds_read_b64_tr_b16 v[12:13], v6 offset:0
  ds_read_b64_tr_b16 v[14:15], v9 offset:0
  ds_read_b64_tr_b16 v[16:17], v6 offset:8
  ds_read_b64_tr_b16 v[18:19], v9 offset:8
  ds_read_b64_tr_b16 v[20:21], v10
  ds_read_b64_tr_b16 v[22:23], v11
  s_mul_i32 s47, s45, 12
  s_add_u32 s47, s47, s48
  s_mul_i32 s47, s47, 36
  s_add_u32 s47, s47, s46
  s_mul_i32 s47, s47, 3072
  s_add_u32 s47, s47, 0x300000
  s_lshl_b32 s42, s41, 7
  s_add_u32 s42, s42, s39
  s_lshl_b32 s43, s41, 6
  s_add_u32 s43, s43, s39
  s_add_u32 s43, s43, 256
  v_lshlrev_b32 v7, 5, v3
  v_add_u32 v7, s42, v7
  v_lshlrev_b32 v8, 4, v3
  v_add_u32 v8, s43, v8
  s_waitcnt lgkmcnt(4)
  buffer_store_dwordx4 v[12:15], v2, s[8:11], s47 offen offset:0 sc1
  v_mfma_f32_16x16x32_bf16 v[28:31], v[12:15], v[40:43], 0
  s_waitcnt lgkmcnt(2)
  buffer_store_dwordx4 v[16:19], v2, s[8:11], s47 offen offset:1024 sc1
  v_mfma_f32_16x16x32_bf16 v[32:35], v[16:19], v[40:43], 0
  s_waitcnt lgkmcnt(0)
  buffer_store_dwordx4 v[20:23], v2, s[8:11], s47 offen offset:2048 sc1
  v_mfma_f32_16x16x32_bf16 v[36:39], v[20:23], v[40:43], 0
  s_nop 7
  ds_write_b128 v7, v[28:31]
  ds_write_b128 v7, v[32:35] offset:16
  ds_write_b128 v8, v[36:39]
  s_waitcnt lgkmcnt(0)
  s_branch L_P_next
L_Pp_wq:
  v_lshl_add_u32 v6, v3, 3, v46
  s_movk_i32 s38, 1152
  v_mul_u32_u24 v6, s38, v6
  v_lshl_add_u32 v6, v47, 3, v6
  s_mul_i32 s38, s48, 96
  s_add_u32 s38, s38, s50
  v_add_u32 v6, s38, v6
  ds_read_b64_tr_b16 v[12:13], v6 offset:0
  ds_read_b64_tr_b16 v[14:15], v6 offset:4608
  ds_read_b64_tr_b16 v[16:17], v6 offset:32
  ds_read_b64_tr_b16 v[18:19], v6 offset:4640
  ds_read_b64_tr_b16 v[20:21], v6 offset:64
  ds_read_b64_tr_b16 v[22:23], v6 offset:4672
  s_mul_i32 s40, s45, 9
  v_bfe_u32 v7, v1, 3, 1
  s_mul_i32 s38, s48, 6
  s_add_u32 s38, s38, 0
  v_add_u32 v7, s38, v7
  s_mov_b32 s38, 57
  v_mul_u32_u24 v8, s38, v7
  v_lshrrev_b32 v8, 9, v8
  v_mul_u32_u24 v9, 9, v8
  v_sub_u32 v9, v7, v9
  v_add_u32 v9, s40, v9
  v_mul_u32_u24 v8, 28, v8
  v_add_u32 v8, v8, v9
  v_lshrrev_b32 v9, 1, v8
  s_movk_i32 s38, 18432
  v_mul_u32_u24 v9, s38, v9
  v_and_b32 v8, 1, v8
  v_lshl_add_u32 v9, v8, 7, v9
  v_lshl_add_u32 v9, v3, 8, v9
  v_and_b32 v8, 7, v1
  v_lshl_add_u32 v24, v8, 4, v9
  v_bfe_u32 v7, v1, 3, 1
  s_mul_i32 s38, s48, 6
  s_add_u32 s38, s38, 2
  v_add_u32 v7, s38, v7
  s_mov_b32 s38, 57
  v_mul_u32_u24 v8, s38, v7
  v_lshrrev_b32 v8, 9, v8
  v_mul_u32_u24 v9, 9, v8
  v_sub_u32 v9, v7, v9
  v_add_u32 v9, s40, v9
  v_mul_u32_u24 v8, 28, v8
  v_add_u32 v8, v8, v9
  v_lshrrev_b32 v9, 1, v8
  s_movk_i32 s38, 18432
  v_mul_u32_u24 v9, s38, v9
  v_and_b32 v8, 1, v8
  v_lshl_add_u32 v9, v8, 7, v9
  v_lshl_add_u32 v9, v3, 8, v9
  v_and_b32 v8, 7, v1
  v_lshl_add_u32 v25, v8, 4, v9
  v_bfe_u32 v7, v1, 3, 1
  s_mul_i32 s38, s48, 6
  s_add_u32 s38, s38, 4
  v_add_u32 v7, s38, v7
  s_mov_b32 s38, 57
  v_mul_u32_u24 v8, s38, v7
  v_lshrrev_b32 v8, 9, v8
  v_mul_u32_u24 v9, 9, v8
  v_sub_u32 v9, v7, v9
  v_add_u32 v9, s40, v9
  v_mul_u32_u24 v8, 28, v8
  v_add_u32 v8, v8, v9
  v_lshrrev_b32 v9, 1, v8
  s_movk_i32 s38, 18432
  v_mul_u32_u24 v9, s38, v9
  v_and_b32 v8, 1, v8
  v_lshl_add_u32 v9, v8, 7, v9
  v_lshl_add_u32 v9, v3, 8, v9
  v_and_b32 v8, 7, v1
  v_lshl_add_u32 v26, v8, 4, v9
  s_lshl_b32 s47, s46, 10
  s_and_b32 s42, s48, 1
  s_mul_i32 s42, s42, 192
  s_add_u32 s42, s42, s39
  v_lshlrev_b32 v7, 4, v3
  v_add_u32 v7, s42, v7
  s_waitcnt lgkmcnt(0)
  buffer_store_dwordx4 v[12:15], v24, s[8:11], s47 offen sc1
  v_mfma_f32_16x16x32_bf16 v[28:31], v[12:15], v[40:43], 0
  buffer_store_dwordx4 v[16:19], v25, s[8:11], s47 offen sc1
  v_mfma_f32_16x16x32_bf16 v[32:35], v[16:19], v[40:43], 0
  buffer_store_dwordx4 v[20:23], v26, s[8:11], s47 offen sc1
  v_mfma_f32_16x16x32_bf16 v[36:39], v[20:23], v[40:43], 0
  s_nop 7
  ds_write_b128 v7, v[28:31] offset:0
  ds_write_b128 v7, v[32:35] offset:64
  ds_write_b128 v7, v[36:39] offset:128
  s_waitcnt lgkmcnt(0)
  s_branch L_P_next
L_Pp_w2:
  s_mul_i32 s40, s46, 86
  s_lshr_b32 s40, s40, 8
  s_mul_i32 s41, s40, 3
  s_sub_u32 s41, s46, s41
  s_cmp_eq_u32 s41, 2
  s_cselect_b32 s44, 2, 3
  s_movk_i32 s43, 4608
  s_cselect_b32 s43, 18432, s43
  v_lshlrev_b32 v6, s44, v3
  v_add_u32 v6, v6, v46
  s_movk_i32 s38, 1152
  v_mul_u32_u24 v6, s38, v6
  s_mul_i32 s38, s48, 96
  s_add_u32 s38, s38, s50
  v_add_u32 v6, s38, v6
  v_lshl_add_u32 v10, v47, 3, v6
  v_add_u32 v10, 64, v10
  v_lshl_add_u32 v6, v47, 4, v6
  v_add_u32 v9, s43, v6
  v_add_u32 v11, s43, v10
  ds_read_b64_tr_b16 v[12:13], v6 offset:0
  ds_read_b64_tr_b16 v[14:15], v9 offset:0
  ds_read_b64_tr_b16 v[16:17], v6 offset:8
  ds_read_b64_tr_b16 v[18:19], v9 offset:8
  ds_read_b64_tr_b16 v[20:21], v10
  ds_read_b64_tr_b16 v[22:23], v11
  s_mul_i32 s47, s45, 12
  s_add_u32 s47, s47, s48
  s_mul_i32 s47, s47, 36
  s_add_u32 s47, s47, s46
  s_add_u32 s47, s47, 18
  s_mul_i32 s47, s47, 3072
  s_add_u32 s47, s47, 0x300000
  s_waitcnt lgkmcnt(4)
  buffer_store_dwordx4 v[12:15], v2, s[8:11], s47 offen offset:0 sc1
  s_waitcnt lgkmcnt(2)
  buffer_store_dwordx4 v[16:19], v2, s[8:11], s47 offen offset:1024 sc1
  s_waitcnt lgkmcnt(0)
  buffer_store_dwordx4 v[20:23], v2, s[8:11], s47 offen offset:2048 sc1
  s_branch L_P_next
L_Pp_wo:
  s_lshl_b32 s44, s48, 2
  v_add_u32 v6, s44, v3
  v_min_u32 v6, 44, v6
  s_mov_b32 s38, 52
  v_mul_u32_u24 v8, s38, v6
  v_lshrrev_b32 v8, 8, v8
  v_mul_u32_u24 v7, 5, v8
  v_sub_u32 v7, v6, v7
  v_lshrrev_b32 v9, 1, v8
  v_mul_u32_u24 v9, 18, v9
  v_and_b32 v10, 1, v8
  v_lshl_add_u32 v9, v10, 3, v9
  v_add_u32 v9, v9, v46
  v_add_u32 v10, 4, v9
  v_lshrrev_b32 v11, 1, v46
  v_mul_u32_u24 v11, 18, v11
  v_and_b32 v16, 1, v46
  v_add3_u32 v11, v11, v16, 16
  v_add_u32 v16, 36, v11
  v_cmp_eq_u32 vcc, 8, v8
  s_nop 1
  v_cndmask_b32 v9, v9, v11, vcc
  v_cndmask_b32 v10, v10, v16, vcc
  s_movk_i32 s38, 144
  v_mul_u32_u24 v9, s38, v9
  v_mul_u32_u24 v10, s38, v10
  v_lshlrev_b32 v11, 5, v7
  v_lshl_add_u32 v11, v47, 3, v11
  v_add_u32 v11, s50, v11
  v_add_u32 v9, v9, v11
  v_add_u32 v10, v10, v11
  ds_read_b64_tr_b16 v[12:13], v9
  ds_read_b64_tr_b16 v[14:15], v10
  s_movk_i32 s38, 18432
  v_mul_u32_u24 v7, s38, v7
  s_mul_i32 s38, s46, 9
  v_add_u32 v8, s38, v8
  v_lshl_add_u32 v7, v8, 8, v7
  v_lshl_add_u32 v7, v4, 4, v7
  s_mul_i32 s44, s45, 92160
  s_add_u32 s44, s44, 0x200000
  s_waitcnt lgkmcnt(0)
  buffer_store_dwordx4 v[12:15], v7, s[8:11], s44 offen sc1
  s_branch L_P_next
L_Pp_x0:
  v_and_b32 v6, 31, v1
  v_lshrrev_b32 v7, 5, v1
  s_movk_i32 s38, 1152
  v_mul_u32_u24 v8, s38, v6
  v_lshl_add_u32 v8, v7, 4, v8
  s_mul_i32 s38, s48, 96
  s_add_u32 s38, s38, s50
  v_add_u32 v8, s38, v8
  ds_read_b128 v[12:15], v8 offset:0
  ds_read_b128 v[16:19], v8 offset:32
  ds_read_b128 v[20:23], v8 offset:64
  v_lshlrev_b32 v9, 10, v7
  v_lshl_add_u32 v9, v6, 4, v9
  s_lshr_b32 s40, s46, 1
  s_mul_i32 s40, s40, 73728
  s_and_b32 s41, s46, 1
  s_lshl_b32 s41, s41, 9
  s_add_u32 s40, s40, s41
  s_mul_i32 s41, s48, 6144
  s_add_u32 s40, s40, s41
  s_add_u32 s40, s40, 0x4c00000
  s_add_u32 s41, s40, 4096
  s_waitcnt lgkmcnt(2)
  buffer_store_dwordx4 v[12:15], v9, s[8:11], s40 offen offset:0 sc1
  s_waitcnt lgkmcnt(1)
  buffer_store_dwordx4 v[16:19], v9, s[8:11], s40 offen offset:2048 sc1
  s_waitcnt lgkmcnt(0)
  buffer_store_dwordx4 v[20:23], v9, s[8:11], s41 offen offset:0 sc1
L_P_next:
  s_add_u32 s48, s48, 1
  s_bitcmp1_b32 s48, 0
  s_nop 3
  s_cbranch_scc1 L_P_vw
  s_cmp_lt_u32 s51, 56
  s_cbranch_scc1 L_P_csq
  s_cmp_lt_u32 s51, 184
  s_cbranch_scc1 L_P_tag
  s_cmp_ge_u32 s51, 328
  s_cbranch_scc1 L_P_tag
  s_mul_i32 s42, s46, 18432
  s_mul_i32 s40, s45, 2304
  s_add_u32 s42, s42, s40
  s_add_u32 s42, s42, 0xe40000
  s_mul_i32 s40, s49, 384
  s_add_u32 s42, s42, s40
  v_add_u32 v6, s39, v2
  s_waitcnt lgkmcnt(0)
  ds_read_b128 v[28:31], v6
  s_mov_b64 exec, 0xffffff
  s_waitcnt lgkmcnt(0)
  buffer_store_dwordx4 v[28:31], v2, s[8:11], s42 offen sc1
  s_mov_b64 exec, -1
  s_branch L_P_tag
L_P_csq:
  s_mul_i32 s42, s51, 2304
  s_add_u32 s42, s42, 0xea0000
  s_mul_i32 s40, s49, 384
  s_add_u32 s42, s42, s40
  v_add_u32 v6, s39, v2
  s_waitcnt lgkmcnt(0)
  ds_read_b128 v[28:31], v6
  s_mov_b64 exec, 0xffffff
  s_waitcnt lgkmcnt(0)
  buffer_store_dwordx4 v[28:31], v2, s[8:11], s42 offen sc1
  s_mov_b64 exec, -1
L_P_tag:
  v_mov_b32 v8, 0
  s_mov_b32 s38, 0x20000
L_tag_1:
  global_load_dwordx2 v[10:11], v8, s[34:35] sc1
  s_waitcnt vmcnt(0)
  v_readfirstlane_b32 s62, v10
  v_readfirstlane_b32 s63, v11
  s_sub_u32 s38, s38, 1
  s_cmp_eq_u32 s38, 0
  s_cbranch_scc1 L_tag_1_ok
  s_and_b32 s36, s62, s63
  s_bitcmp1_b32 s36, 0
  s_cbranch_scc1 L_tag_1_ok
  s_sleep 2
  s_branch L_tag_1
L_tag_1_ok:
  s_mov_b32 s27, 163328
  s_cmp_lt_u32 s51, 56
  s_cbranch_scc1 L_P_pq
  s_add_u32 s36, s27, 264
  s_lshl_b32 s37, s51, 7
  s_add_u32 s37, s37, 0xf80000
  s_lshl_b32 s38, s56, 2
  s_add_u32 s36, s36, s38
  s_waitcnt vmcnt(0)
  v_mov_b32 v8, s36
  v_mov_b32 v9, 1
  s_mov_b64 exec, 1
  ds_add_rtn_u32 v8, v8, v9
  s_waitcnt lgkmcnt(0)
  v_readfirstlane_b32 s36, v8
  v_mov_b32 v8, s62
  v_mov_b32 v9, s63
  v_lshlrev_b32 v10, 13, v1
  s_nop 0
  s_cmp_lg_u32 s36, 5
  s_cbranch_scc1 L_pub_2
  buffer_store_dwordx2 v[8:9], v10, s[8:11], s37 offen sc1
L_pub_2:
  s_mov_b64 exec, -1
  s_branch L_P_end
L_P_pq:
  s_add_u32 s36, s27, 264
  s_lshl_b32 s37, s51, 7
  s_add_u32 s37, s37, 0xf90000
  s_lshl_b32 s38, s56, 2
  s_add_u32 s36, s36, s38
  s_waitcnt vmcnt(0)
  v_mov_b32 v8, s36
  v_mov_b32 v9, 1
  s_mov_b64 exec, 1
  ds_add_rtn_u32 v8, v8, v9
  s_waitcnt lgkmcnt(0)
  v_readfirstlane_b32 s36, v8
  s_mov_b64 exec, 0xff
  v_mov_b32 v8, s62
  v_mov_b32 v9, s63
  v_lshlrev_b32 v10, 13, v1
  s_nop 0
  s_cmp_lg_u32 s36, 5
  s_cbranch_scc1 L_pub_3
  buffer_store_dwordx2 v[8:9], v10, s[8:11], s37 offen sc1
L_pub_3:
  s_mov_b64 exec, -1
  s_branch L_P_end
L_P_done:
  v_mov_b32 v8, 0
  s_mov_b32 s38, 0x20000
L_tag_4:
  global_load_dwordx2 v[10:11], v8, s[34:35] sc1
  s_waitcnt vmcnt(0)
  v_readfirstlane_b32 s62, v10
  v_readfirstlane_b32 s63, v11
  s_sub_u32 s38, s38, 1
  s_cmp_eq_u32 s38, 0
  s_cbranch_scc1 L_tag_4_ok
  s_and_b32 s36, s62, s63
  s_bitcmp1_b32 s36, 0
  s_cbranch_scc1 L_tag_4_ok
  s_sleep 2
  s_branch L_tag_4
L_tag_4_ok:
L_P_end:
  s_and_b32 s36, s2, 7
  s_lshr_b32 s37, s2, 3
  s_and_b32 s30, s36, 1
  s_lshl_b32 s30, s30, 2
  s_and_b32 s38, s37, 3
  s_add_u32 s30, s30, s38
  s_lshr_b32 s29, s36, 1
  s_lshl_b32 s29, s29, 3
  s_lshr_b32 s33, s37, 2
  s_add_u32 s29, s29, s33
  s_and_b32 s36, s2, 7
  s_lshr_b32 s37, s2, 3
  s_and_b32 s32, s36, 3
  s_lshl_b32 s32, s32, 1
  s_and_b32 s38, s37, 1
  s_add_u32 s32, s32, s38
  s_lshr_b32 s31, s36, 2
  s_lshl_b32 s31, s31, 4
  s_lshr_b32 s33, s37, 1
  s_add_u32 s31, s31, s33
  s_mov_b32 s34, 0
  s_mul_i32 s36, s33, 43
  s_lshr_b32 s36, s36, 8
  s_mul_i32 s35, s36, 6
  s_sub_u32 s35, s33, s35
  s_mov_b32 s35, 0
  s_lshr_b32 s60, s3, 2
  s_and_b32 s61, s3, 3
  s_mov_b32 s57, 0
  s_mov_b32 s22, 0
  s_mov_b32 s23, 0x4c00000
  s_mov_b32 s24, 0x1000000
  s_mov_b32 s25, 0x1400000
  s_mov_b32 s26, 0x2400000
  s_mov_b32 s28, 0xf00000
  s_mov_b32 s27, 163328
  s_barrier
  s_cmp_lg_u32 s3, 0
  s_cbranch_scc1 L_M_bar
  s_lshl_b32 s36, s29, 1
  s_sub_u32 s36, s36, 1
  v_add_u32 v9, s36, v1
  v_max_i32 v9, 0, v9
  v_and_b32 v10, 7, v9
  v_lshrrev_b32 v9, 3, v9
  v_lshl_add_u32 v9, v10, 3, v9
  v_add_u32 v9, 56, v9
  v_lshlrev_b32 v8, 7, v9
  s_mov_b32 s37, 0xf80000
  s_mov_b32 exec_lo, 0x7
  s_mov_b32 exec_hi, 0x0
  s_mov_b32 s38, 0x20000
L_aw_5:
  v_mov_b32 v10, 0
  v_mov_b32 v11, 0
  buffer_atomic_or_x2 v[10:11], v8, s[8:11], s37 offen sc0 sc1
  s_waitcnt vmcnt(0)
  v_cmp_ne_u64 vcc, s[62:63], v[10:11]
  s_sub_u32 s38, s38, 1
  s_nop 3
  s_cbranch_vccz L_aw_5_ok
  s_cmp_eq_u32 s38, 0
  s_cbranch_scc1 L_aw_5_ok
  s_sleep 3
  s_branch L_aw_5
L_aw_5_ok:
  s_mov_b64 exec, -1
L_M_bar:
  s_barrier
L_layer:
  s_mul_i32 s39, s29, 73728
  s_add_u32 s39, s39, s23
  s_mul_i32 s36, s3, 6144
  s_add_u32 s37, s39, s36
  s_add_u32 s38, s37, 4096
  buffer_load_dwordx4 v[8:11], v2, s[8:11], s37 offen offset:0 sc1
  buffer_load_dwordx4 v[12:15], v2, s[8:11], s37 offen offset:1024 sc1
  buffer_load_dwordx4 v[16:19], v2, s[8:11], s37 offen offset:2048 sc1
  buffer_load_dwordx4 v[20:23], v2, s[8:11], s37 offen offset:3072 sc1
  buffer_load_dwordx4 v[24:27], v2, s[8:11], s38 offen offset:0 sc1
  buffer_load_dwordx4 v[28:31], v2, s[8:11], s38 offen offset:1024 sc1
  v_lshlrev_b32 v5, 10, v3
  v_lshl_add_u32 v5, v4, 4, v5
  s_cmp_eq_u32 s29, 0
  s_cselect_b32 s38, 0x70000000, 0
  v_add_u32 v7, s38, v5
  s_mul_i32 s50, s60, 6
  s_add_u32 s50, s50, s61
  s_lshl_b32 s37, s50, 12
  s_add_u32 s37, s37, s39
  s_sub_u32 s37, s37, 72960
  buffer_load_dwordx4 v[32:35], v7, s[8:11], s37 offen sc1
  s_cmp_ge_u32 s61, 2
  s_cselect_b32 s38, 0x70000000, 0
  v_or_b32 v6, s38, v7
  s_add_u32 s37, s37, 16384
  buffer_load_dwordx4 v[36:39], v6, s[8:11], s37 offen sc1
  s_mov_b32 s40, 0x8d2064b9
  s_mov_b32 s41, 0x0
  s_lshl_b32 s42, s3, 2
  s_lshr_b64 s[40:41], s[40:41], s42
  s_and_b32 s40, s40, 15
  s_mul_i32 s41, s30, 14
  s_add_u32 s41, s41, s40
  s_mul_i32 s42, s3, 13824
  s_mul_i32 s43, s30, 288
  s_add_u32 s42, s42, s43
  s_add_u32 s42, s42, 0xea0000
  s_mul_i32 s41, s41, 18432
  s_min_u32 s59, s3, 9
  s_cmp_ge_u32 s59, 5
  s_cselect_b32 s45, 1, 0
  s_mul_i32 s46, s45, 5
  s_sub_u32 s46, s59, s46
  s_mul_i32 s58, s30, 5
  s_add_u32 s58, s58, s46
  s_mul_i32 s58, s58, 18432
  s_mul_i32 s59, s45, 9216
  s_add_u32 s58, s58, s59
  s_add_u32 s58, s58, 0x200000
  s_mul_i32 s47, s32, 12
  s_add_u32 s47, s47, s3
  s_mul_i32 s47, s47, 110592
  s_add_u32 s47, s47, 0x300000
  s_mul_i32 s48, s34, 3072
  s_add_u32 s48, s48, s47
  s_add_u32 s49, s47, 55296
  s_cmp_lg_u32 s22, 0
  s_cbranch_scc1 L_A_np
  s_cmp_lg_u32 s3, 9
  s_cbranch_scc1 L_A_np
  s_and_b32 s37, s2, 7
  s_lshl_b32 s37, s37, 6
  s_add_u32 s37, s37, 512
  v_add_u32 v44, s37, v1
  s_add_u32 s37, s30, -312
  v_lshlrev_b32 v45, 3, v1
  v_add_u32 v45, s37, v45
  v_cmp_gt_u32 vcc, 54, v1
  s_nop 1
  v_cndmask_b32 v44, v45, v44, vcc
  v_lshlrev_b32 v44, 7, v44
  s_mov_b32 s37, 0xf80000
  s_mov_b32 exec_lo, 0xffffffff
  s_mov_b32 exec_hi, 0x3fffffff
  s_mov_b32 s38, 0x20000
L_aw_6:
  v_mov_b32 v46, 0
  v_mov_b32 v47, 0
  buffer_atomic_or_x2 v[46:47], v44, s[8:11], s37 offen sc0 sc1
  s_waitcnt vmcnt(0)
  v_cmp_ne_u64 vcc, s[62:63], v[46:47]
  s_sub_u32 s38, s38, 1
  s_nop 3
  s_cbranch_vccz L_aw_6_ok
  s_cmp_eq_u32 s38, 0
  s_cbranch_scc1 L_aw_6_ok
  s_sleep 3
  s_branch L_aw_6
L_aw_6_ok:
  s_mov_b64 exec, -1
  s_mov_b32 s57, s36
  s_add_u32 s36, s27, 108
  v_mov_b32 v44, s36
  v_mov_b32 v45, 1
  s_mov_b64 exec, 1
  ds_add_u32 v44, v45
  s_mov_b64 exec, -1
  s_mov_b32 s36, s57
L_A_np:
  s_mov_b32 s38, 0x3f803f80
  v_add_u32 v6, s36, v2
  s_waitcnt vmcnt(7)
  ds_write_b128 v6, v[8:11] offset:0
  v_dot2_f32_bf16 v40, v8, s38, 0
  v_dot2_f32_bf16 v41, v8, v8, 0
  v_dot2_f32_bf16 v40, v9, s38, v40
  v_dot2_f32_bf16 v41, v9, v9, v41
  v_dot2_f32_bf16 v40, v10, s38, v40
  v_dot2_f32_bf16 v41, v10, v10, v41
  v_dot2_f32_bf16 v40, v11, s38, v40
  v_dot2_f32_bf16 v41, v11, v11, v41
  s_waitcnt vmcnt(6)
  ds_write_b128 v6, v[12:15] offset:1024
  v_dot2_f32_bf16 v40, v12, s38, v40
  v_dot2_f32_bf16 v41, v12, v12, v41
  v_dot2_f32_bf16 v40, v13, s38, v40
  v_dot2_f32_bf16 v41, v13, v13, v41
  v_dot2_f32_bf16 v40, v14, s38, v40
  v_dot2_f32_bf16 v41, v14, v14, v41
  v_dot2_f32_bf16 v40, v15, s38, v40
  v_dot2_f32_bf16 v41, v15, v15, v41
  s_waitcnt vmcnt(5)
  ds_write_b128 v6, v[16:19] offset:2048
  v_dot2_f32_bf16 v40, v16, s38, v40
  v_dot2_f32_bf16 v41, v16, v16, v41
  v_dot2_f32_bf16 v40, v17, s38, v40
  v_dot2_f32_bf16 v41, v17, v17, v41
  v_dot2_f32_bf16 v40, v18, s38, v40
  v_dot2_f32_bf16 v41, v18, v18, v41
  v_dot2_f32_bf16 v40, v19, s38, v40
  v_dot2_f32_bf16 v41, v19, v19, v41
  s_waitcnt vmcnt(4)
  ds_write_b128 v6, v[20:23] offset:3072
  v_dot2_f32_bf16 v40, v20, s38, v40
  v_dot2_f32_bf16 v41, v20, v20, v41
  v_dot2_f32_bf16 v40, v21, s38, v40
  v_dot2_f32_bf16 v41, v21, v21, v41
  v_dot2_f32_bf16 v40, v22, s38, v40
  v_dot2_f32_bf16 v41, v22, v22, v41
  v_dot2_f32_bf16 v40, v23, s38, v40
  v_dot2_f32_bf16 v41, v23, v23, v41
  s_waitcnt vmcnt(3)
  ds_write_b128 v6, v[24:27] offset:4096
  v_dot2_f32_bf16 v40, v24, s38, v40
  v_dot2_f32_bf16 v41, v24, v24, v41
  v_dot2_f32_bf16 v40, v25, s38, v40
  v_dot2_f32_bf16 v41, v25, v25, v41
  v_dot2_f32_bf16 v40, v26, s38, v40
  v_dot2_f32_bf16 v41, v26, v26, v41
  v_dot2_f32_bf16 v40, v27, s38, v40
  v_dot2_f32_bf16 v41, v27, v27, v41
  s_waitcnt vmcnt(2)
  ds_write_b128 v6, v[28:31] offset:5120
  v_dot2_f32_bf16 v40, v28, s38, v40
  v_dot2_f32_bf16 v41, v28, v28, v41
  v_dot2_f32_bf16 v40, v29, s38, v40
  v_dot2_f32_bf16 v41, v29, v29, v41
  v_dot2_f32_bf16 v40, v30, s38, v40
  v_dot2_f32_bf16 v41, v30, v30, v41
  v_dot2_f32_bf16 v40, v31, s38, v40
  v_dot2_f32_bf16 v41, v31, v31, v41
  s_waitcnt vmcnt(1)
  s_lshl_b32 s37, s50, 10
  s_add_u32 s37, s37, 73728
  v_add_u32 v6, s37, v2
  ds_write_b128 v6, v[32:35]
  v_dot2_f32_bf16 v42, v32, s38, 0
  v_dot2_f32_bf16 v43, v32, v32, 0
  v_dot2_f32_bf16 v42, v33, s38, v42
  v_dot2_f32_bf16 v43, v33, v33, v43
  v_dot2_f32_bf16 v42, v34, s38, v42
  v_dot2_f32_bf16 v43, v34, v34, v43
  v_dot2_f32_bf16 v42, v35, s38, v42
  v_dot2_f32_bf16 v43, v35, v35, v43
  s_waitcnt vmcnt(0)
  v_dot2_f32_bf16 v42, v36, s38, v42
  v_dot2_f32_bf16 v43, v36, v36, v43
  v_dot2_f32_bf16 v42, v37, s38, v42
  v_dot2_f32_bf16 v43, v37, v37, v43
  v_dot2_f32_bf16 v42, v38, s38, v42
  v_dot2_f32_bf16 v43, v38, v38, v43
  v_dot2_f32_bf16 v42, v39, s38, v42
  v_dot2_f32_bf16 v43, v39, v39, v43
  s_cmp_ge_u32 s61, 2
  s_cbranch_scc1 L_A_xs
  ds_write_b128 v6, v[36:39] offset:4096
L_A_xs:
  s_lshl_b32 s37, s3, 9
  v_lshlrev_b32 v6, 3, v1
  v_add_u32 v6, s37, v6
  v_add_u32 v6, 92160, v6
  ds_write_b64 v6, v[40:41]
  ds_write_b64 v6, v[42:43] offset:6144
  s_waitcnt lgkmcnt(0)
  s_add_u32 s36, s27, 96
  s_lshl_b32 s37, s60, 2
  s_add_u32 s36, s36, s37
  v_mov_b32 v44, s36
  v_mov_b32 v45, 1
  s_mov_b64 exec, 1
  ds_add_u32 v44, v45
  s_mov_b64 exec, -1
  s_waitcnt lgkmcnt(0)
  s_cmp_lg_u32 s22, 0
  s_cbranch_scc1 L_A_wqok
  s_add_u32 s36, s27, 108
  v_mov_b32 v44, s36
L_lw_7:
  ds_read_b32 v45, v44
  s_waitcnt lgkmcnt(0)
  v_readfirstlane_b32 s36, v45
  s_nop 3
  s_cmp_ge_u32 s36, 1
  s_cbranch_scc1 L_lw_7_ok
  s_sleep 2
  s_branch L_lw_7
L_lw_7_ok:
L_A_wqok:
  s_cmp_ge_u32 s3, 8
  s_cbranch_scc1 L_A_free
  v_add_u32 v6, 49152, v5
  v_add_u32 v7, 73728, v2
  s_cmp_ge_u32 s3, 6
  s_cbranch_scc1 L_A_single
  s_cmp_ge_u32 s3, 4
  s_cbranch_scc1 L_A_qpair
  s_add_u32 s43, s41, 0
  s_add_u32 s44, s41, 18432
  buffer_load_dwordx4 v[88:91], v2, s[8:11], s43 offen sc1
  buffer_load_dwordx4 v[92:95], v2, s[8:11], s44 offen sc1
  s_add_u32 s43, s41, 1024
  s_add_u32 s44, s41, 19456
  buffer_load_dwordx4 v[96:99], v2, s[8:11], s43 offen sc1
  buffer_load_dwordx4 v[100:103], v2, s[8:11], s44 offen sc1
  s_add_u32 s43, s41, 2048
  s_add_u32 s44, s41, 20480
  buffer_load_dwordx4 v[104:107], v2, s[8:11], s43 offen sc1
  buffer_load_dwordx4 v[108:111], v2, s[8:11], s44 offen sc1
  s_add_u32 s43, s41, 3072
  s_add_u32 s44, s41, 21504
  buffer_load_dwordx4 v[112:115], v2, s[8:11], s43 offen sc1
  buffer_load_dwordx4 v[116:119], v2, s[8:11], s44 offen sc1
  s_add_u32 s43, s41, 4096
  s_add_u32 s44, s41, 22528
  buffer_load_dwordx4 v[120:123], v2, s[8:11], s43 offen sc1
  buffer_load_dwordx4 v[124:127], v2, s[8:11], s44 offen sc1
  s_add_u32 s36, s27, 96
  v_mov_b32 v160, s36
L_lw_8:
  ds_read_b32 v161, v160
  s_waitcnt lgkmcnt(0)
  v_readfirstlane_b32 s36, v161
  s_nop 3
  s_cmp_ge_u32 s36, 4
  s_cbranch_scc1 L_lw_8_ok
  s_sleep 2
  s_branch L_lw_8
L_lw_8_ok:
  ds_read_b128 v[48:51], v7 offset:0
  ds_read_b128 v[52:55], v5 offset:0
  ds_read_b128 v[56:59], v5 offset:256
  ds_read_b128 v[60:63], v5 offset:512
  ds_read_b128 v[64:67], v5 offset:768
  ds_read_b128 v[68:71], v7 offset:1024
  ds_read_b128 v[72:75], v5 offset:4096
  ds_read_b128 v[76:79], v5 offset:4352
  ds_read_b128 v[80:83], v5 offset:4608
  ds_read_b128 v[84:87], v5 offset:4864
  s_waitcnt vmcnt(8) lgkmcnt(5)
  v_mfma_f32_16x16x32_bf16 v[8:11], v[88:91], v[48:51], 0
  v_mfma_f32_16x16x32_bf16 v[12:15], v[88:91], v[52:55], 0
  v_mfma_f32_16x16x32_bf16 v[16:19], v[88:91], v[56:59], 0
  v_mfma_f32_16x16x32_bf16 v[20:23], v[88:91], v[60:63], 0
  v_mfma_f32_16x16x32_bf16 v[24:27], v[88:91], v[64:67], 0
  v_mfma_f32_16x16x32_bf16 v[44:47], v[92:95], v[64:67], 0
  v_mfma_f32_16x16x32_bf16 v[40:43], v[92:95], v[60:63], 0
  v_mfma_f32_16x16x32_bf16 v[36:39], v[92:95], v[56:59], 0
  v_mfma_f32_16x16x32_bf16 v[32:35], v[92:95], v[52:55], 0
  v_mfma_f32_16x16x32_bf16 v[28:31], v[92:95], v[48:51], 0
  s_add_u32 s43, s41, 5120
  s_add_u32 s44, s41, 23552
  buffer_load_dwordx4 v[128:131], v2, s[8:11], s43 offen sc1
  buffer_load_dwordx4 v[132:135], v2, s[8:11], s44 offen sc1
  ds_read_b128 v[48:51], v7 offset:2048
  ds_read_b128 v[52:55], v5 offset:8192
  ds_read_b128 v[56:59], v5 offset:8448
  ds_read_b128 v[60:63], v5 offset:8704
  ds_read_b128 v[64:67], v5 offset:8960
  s_waitcnt vmcnt(8) lgkmcnt(5)
  v_mfma_f32_16x16x32_bf16 v[8:11], v[96:99], v[68:71], v[8:11]
  v_mfma_f32_16x16x32_bf16 v[12:15], v[96:99], v[72:75], v[12:15]
  v_mfma_f32_16x16x32_bf16 v[16:19], v[96:99], v[76:79], v[16:19]
  v_mfma_f32_16x16x32_bf16 v[20:23], v[96:99], v[80:83], v[20:23]
  v_mfma_f32_16x16x32_bf16 v[24:27], v[96:99], v[84:87], v[24:27]
  v_mfma_f32_16x16x32_bf16 v[44:47], v[100:103], v[84:87], v[44:47]
  v_mfma_f32_16x16x32_bf16 v[40:43], v[100:103], v[80:83], v[40:43]
  v_mfma_f32_16x16x32_bf16 v[36:39], v[100:103], v[76:79], v[36:39]
  v_mfma_f32_16x16x32_bf16 v[32:35], v[100:103], v[72:75], v[32:35]
  v_mfma_f32_16x16x32_bf16 v[28:31], v[100:103], v[68:71], v[28:31]
  s_add_u32 s43, s41, 6144
  s_add_u32 s44, s41, 24576
  buffer_load_dwordx4 v[136:139], v2, s[8:11], s43 offen sc1
  buffer_load_dwordx4 v[140:143], v2, s[8:11], s44 offen sc1
  ds_read_b128 v[68:71], v7 offset:3072
  ds_read_b128 v[72:75], v5 offset:12288
  ds_read_b128 v[76:79], v5 offset:12544
  ds_read_b128 v[80:83], v5 offset:12800
  ds_read_b128 v[84:87], v5 offset:13056
  s_waitcnt vmcnt(8) lgkmcnt(5)
  v_mfma_f32_16x16x32_bf16 v[8:11], v[104:107], v[48:51], v[8:11]
  v_mfma_f32_16x16x32_bf16 v[12:15], v[104:107], v[52:55], v[12:15]
  v_mfma_f32_16x16x32_bf16 v[16:19], v[104:107], v[56:59], v[16:19]
  v_mfma_f32_16x16x32_bf16 v[20:23], v[104:107], v[60:63], v[20:23]
  v_mfma_f32_16x16x32_bf16 v[24:27], v[104:107], v[64:67], v[24:27]
  v_mfma_f32_16x16x32_bf16 v[44:47], v[108:111], v[64:67], v[44:47]
  v_mfma_f32_16x16x32_bf16 v[40:43], v[108:111], v[60:63], v[40:43]
  v_mfma_f32_16x16x32_bf16 v[36:39], v[108:111], v[56:59], v[36:39]
  v_mfma_f32_16x16x32_bf16 v[32:35], v[108:111], v[52:55], v[32:35]
  v_mfma_f32_16x16x32_bf16 v[28:31], v[108:111], v[48:51], v[28:31]
  s_add_u32 s43, s41, 7168
  s_add_u32 s44, s41, 25600
  buffer_load_dwordx4 v[144:147], v2, s[8:11], s43 offen sc1
  buffer_load_dwordx4 v[148:151], v2, s[8:11], s44 offen sc1
  ds_read_b128 v[48:51], v7 offset:4096
  ds_read_b128 v[52:55], v5 offset:16384
  ds_read_b128 v[56:59], v5 offset:16640
  ds_read_b128 v[60:63], v5 offset:16896
  ds_read_b128 v[64:67], v5 offset:17152
  s_waitcnt vmcnt(8) lgkmcnt(5)
  v_mfma_f32_16x16x32_bf16 v[8:11], v[112:115], v[68:71], v[8:11]
  v_mfma_f32_16x16x32_bf16 v[12:15], v[112:115], v[72:75], v[12:15]
  v_mfma_f32_16x16x32_bf16 v[16:19], v[112:115], v[76:79], v[16:19]
  v_mfma_f32_16x16x32_bf16 v[20:23], v[112:115], v[80:83], v[20:23]
  v_mfma_f32_16x16x32_bf16 v[24:27], v[112:115], v[84:87], v[24:27]
  v_mfma_f32_16x16x32_bf16 v[44:47], v[116:119], v[84:87], v[44:47]
  v_mfma_f32_16x16x32_bf16 v[40:43], v[116:119], v[80:83], v[40:43]
  v_mfma_f32_16x16x32_bf16 v[36:39], v[116:119], v[76:79], v[36:39]
  v_mfma_f32_16x16x32_bf16 v[32:35], v[116:119], v[72:75], v[32:35]
  v_mfma_f32_16x16x32_bf16 v[28:31], v[116:119], v[68:71], v[28:31]
  s_add_u32 s43, s41, 8192
  s_add_u32 s44, s41, 26624
  buffer_load_dwordx4 v[152:155], v2, s[8:11], s43 offen sc1
  buffer_load_dwordx4 v[156:159], v2, s[8:11], s44 offen sc1
  s_add_u32 s43, s41, 9216
  s_add_u32 s44, s41, 27648
  buffer_load_dwordx4 v[88:91], v2, s[8:11], s43 offen sc1
  buffer_load_dwordx4 v[92:95], v2, s[8:11], s44 offen sc1
  s_add_u32 s43, s41, 10240
  s_add_u32 s44, s41, 28672
  buffer_load_dwordx4 v[96:99], v2, s[8:11], s43 offen sc1
  buffer_load_dwordx4 v[100:103], v2, s[8:11], s44 offen sc1
  s_add_u32 s43, s41, 11264
  s_add_u32 s44, s41, 29696
  buffer_load_dwordx4 v[104:107], v2, s[8:11], s43 offen sc1
  buffer_load_dwordx4 v[108:111], v2, s[8:11], s44 offen sc1
  s_add_u32 s43, s41, 12288
  s_add_u32 s44, s41, 30720
  buffer_load_dwordx4 v[112:115], v2, s[8:11], s43 offen sc1
  buffer_load_dwordx4 v[116:119], v2, s[8:11], s44 offen sc1
  ds_read_b128 v[68:71], v7 offset:5120
  ds_read_b128 v[72:75], v5 offset:20480
  ds_read_b128 v[76:79], v5 offset:20736
  ds_read_b128 v[80:83], v5 offset:20992
  ds_read_b128 v[84:87], v5 offset:21248
  s_waitcnt vmcnt(16) lgkmcnt(5)
  v_mfma_f32_16x16x32_bf16 v[8:11], v[120:123], v[48:51], v[8:11]
  v_mfma_f32_16x16x32_bf16 v[12:15], v[120:123], v[52:55], v[12:15]
  v_mfma_f32_16x16x32_bf16 v[16:19], v[120:123], v[56:59], v[16:19]
  v_mfma_f32_16x16x32_bf16 v[20:23], v[120:123], v[60:63], v[20:23]
  v_mfma_f32_16x16x32_bf16 v[24:27], v[120:123], v[64:67], v[24:27]
  v_mfma_f32_16x16x32_bf16 v[44:47], v[124:127], v[64:67], v[44:47]
  v_mfma_f32_16x16x32_bf16 v[40:43], v[124:127], v[60:63], v[40:43]
  v_mfma_f32_16x16x32_bf16 v[36:39], v[124:127], v[56:59], v[36:39]
  v_mfma_f32_16x16x32_bf16 v[32:35], v[124:127], v[52:55], v[32:35]
  v_mfma_f32_16x16x32_bf16 v[28:31], v[124:127], v[48:51], v[28:31]
  s_add_u32 s43, s41, 13312
  s_add_u32 s44, s41, 31744
  buffer_load_dwordx4 v[120:123], v2, s[8:11], s43 offen sc1
  buffer_load_dwordx4 v[124:127], v2, s[8:11], s44 offen sc1
  s_waitcnt vmcnt(16) lgkmcnt(0)
  v_mfma_f32_16x16x32_bf16 v[8:11], v[128:131], v[68:71], v[8:11]
  v_mfma_f32_16x16x32_bf16 v[12:15], v[128:131], v[72:75], v[12:15]
  v_mfma_f32_16x16x32_bf16 v[16:19], v[128:131], v[76:79], v[16:19]
  v_mfma_f32_16x16x32_bf16 v[20:23], v[128:131], v[80:83], v[20:23]
  v_mfma_f32_16x16x32_bf16 v[24:27], v[128:131], v[84:87], v[24:27]
  v_mfma_f32_16x16x32_bf16 v[44:47], v[132:135], v[84:87], v[44:47]
  v_mfma_f32_16x16x32_bf16 v[40:43], v[132:135], v[80:83], v[40:43]
  v_mfma_f32_16x16x32_bf16 v[36:39], v[132:135], v[76:79], v[36:39]
  v_mfma_f32_16x16x32_bf16 v[32:35], v[132:135], v[72:75], v[32:35]
  v_mfma_f32_16x16x32_bf16 v[28:31], v[132:135], v[68:71], v[28:31]
  s_add_u32 s43, s41, 14336
  s_add_u32 s44, s41, 32768
  buffer_load_dwordx4 v[128:131], v2, s[8:11], s43 offen sc1
  buffer_load_dwordx4 v[132:135], v2, s[8:11], s44 offen sc1
  s_add_u32 s36, s27, 100
  v_mov_b32 v160, s36
L_lw_9:
  ds_read_b32 v161, v160
  s_waitcnt lgkmcnt(0)
  v_readfirstlane_b32 s36, v161
  s_nop 3
  s_cmp_ge_u32 s36, 4
  s_cbranch_scc1 L_lw_9_ok
  s_sleep 2
  s_branch L_lw_9
L_lw_9_ok:
  ds_read_b128 v[48:51], v7 offset:6144
  ds_read_b128 v[52:55], v5 offset:24576
  ds_read_b128 v[56:59], v5 offset:24832
  ds_read_b128 v[60:63], v5 offset:25088
  ds_read_b128 v[64:67], v5 offset:25344
  ds_read_b128 v[68:71], v7 offset:7168
  ds_read_b128 v[72:75], v5 offset:28672
  ds_read_b128 v[76:79], v5 offset:28928
  ds_read_b128 v[80:83], v5 offset:29184
  ds_read_b128 v[84:87], v5 offset:29440
  s_waitcnt vmcnt(16) lgkmcnt(5)
  v_mfma_f32_16x16x32_bf16 v[8:11], v[136:139], v[48:51], v[8:11]
  v_mfma_f32_16x16x32_bf16 v[12:15], v[136:139], v[52:55], v[12:15]
  v_mfma_f32_16x16x32_bf16 v[16:19], v[136:139], v[56:59], v[16:19]
  v_mfma_f32_16x16x32_bf16 v[20:23], v[136:139], v[60:63], v[20:23]
  v_mfma_f32_16x16x32_bf16 v[24:27], v[136:139], v[64:67], v[24:27]
  v_mfma_f32_16x16x32_bf16 v[44:47], v[140:143], v[64:67], v[44:47]
  v_mfma_f32_16x16x32_bf16 v[40:43], v[140:143], v[60:63], v[40:43]
  v_mfma_f32_16x16x32_bf16 v[36:39], v[140:143], v[56:59], v[36:39]
  v_mfma_f32_16x16x32_bf16 v[32:35], v[140:143], v[52:55], v[32:35]
  v_mfma_f32_16x16x32_bf16 v[28:31], v[140:143], v[48:51], v[28:31]
  s_add_u32 s43, s41, 15360
  s_add_u32 s44, s41, 33792
  buffer_load_dwordx4 v[136:139], v2, s[8:11], s43 offen sc1
  buffer_load_dwordx4 v[140:143], v2, s[8:11], s44 offen sc1
  ds_read_b128 v[48:51], v7 offset:8192
  ds_read_b128 v[52:55], v5 offset:32768
  ds_read_b128 v[56:59], v5 offset:33024
  ds_read_b128 v[60:63], v5 offset:33280
  ds_read_b128 v[64:67], v5 offset:33536
  s_waitcnt vmcnt(16) lgkmcnt(5)
  v_mfma_f32_16x16x32_bf16 v[8:11], v[144:147], v[68:71], v[8:11]
  v_mfma_f32_16x16x32_bf16 v[12:15], v[144:147], v[72:75], v[12:15]
  v_mfma_f32_16x16x32_bf16 v[16:19], v[144:147], v[76:79], v[16:19]
  v_mfma_f32_16x16x32_bf16 v[20:23], v[144:147], v[80:83], v[20:23]
  v_mfma_f32_16x16x32_bf16 v[24:27], v[144:147], v[84:87], v[24:27]
  v_mfma_f32_16x16x32_bf16 v[44:47], v[148:151], v[84:87], v[44:47]
  v_mfma_f32_16x16x32_bf16 v[40:43], v[148:151], v[80:83], v[40:43]
  v_mfma_f32_16x16x32_bf16 v[36:39], v[148:151], v[76:79], v[36:39]
  v_mfma_f32_16x16x32_bf16 v[32:35], v[148:151], v[72:75], v[32:35]
  v_mfma_f32_16x16x32_bf16 v[28:31], v[148:151], v[68:71], v[28:31]
  s_add_u32 s43, s41, 16384
  s_add_u32 s44, s41, 34816
  buffer_load_dwordx4 v[144:147], v2, s[8:11], s43 offen sc1
  buffer_load_dwordx4 v[148:151], v2, s[8:11], s44 offen sc1
  ds_read_b128 v[68:71], v7 offset:9216
  ds_read_b128 v[72:75], v5 offset:36864
  ds_read_b128 v[76:79], v5 offset:37120
  ds_read_b128 v[80:83], v5 offset:37376
  ds_read_b128 v[84:87], v5 offset:37632
  s_waitcnt vmcnt(16) lgkmcnt(5)
  v_mfma_f32_16x16x32_bf16 v[8:11], v[152:155], v[48:51], v[8:11]
  v_mfma_f32_16x16x32_bf16 v[12:15], v[152:155], v[52:55], v[12:15]
  v_mfma_f32_16x16x32_bf16 v[16:19], v[152:155], v[56:59], v[16:19]
  v_mfma_f32_16x16x32_bf16 v[20:23], v[152:155], v[60:63], v[20:23]
  v_mfma_f32_16x16x32_bf16 v[24:27], v[152:155], v[64:67], v[24:27]
  v_mfma_f32_16x16x32_bf16 v[44:47], v[156:159], v[64:67], v[44:47]
  v_mfma_f32_16x16x32_bf16 v[40:43], v[156:159], v[60:63], v[40:43]
  v_mfma_f32_16x16x32_bf16 v[36:39], v[156:159], v[56:59], v[36:39]
  v_mfma_f32_16x16x32_bf16 v[32:35], v[156:159], v[52:55], v[32:35]
  v_mfma_f32_16x16x32_bf16 v[28:31], v[156:159], v[48:51], v[28:31]
  s_add_u32 s43, s41, 17408
  s_add_u32 s44, s41, 35840
  buffer_load_dwordx4 v[152:155], v2, s[8:11], s43 offen sc1
  buffer_load_dwordx4 v[156:159], v2, s[8:11], s44 offen sc1
  ds_read_b128 v[48:51], v7 offset:10240
  ds_read_b128 v[52:55], v5 offset:40960
  ds_read_b128 v[56:59], v5 offset:41216
  ds_read_b128 v[60:63], v5 offset:41472
  ds_read_b128 v[64:67], v5 offset:41728
  s_waitcnt vmcnt(16) lgkmcnt(5)
  v_mfma_f32_16x16x32_bf16 v[8:11], v[88:91], v[68:71], v[8:11]
  v_mfma_f32_16x16x32_bf16 v[12:15], v[88:91], v[72:75], v[12:15]
  v_mfma_f32_16x16x32_bf16 v[16:19], v[88:91], v[76:79], v[16:19]
  v_mfma_f32_16x16x32_bf16 v[20:23], v[88:91], v[80:83], v[20:23]
  v_mfma_f32_16x16x32_bf16 v[24:27], v[88:91], v[84:87], v[24:27]
  v_mfma_f32_16x16x32_bf16 v[44:47], v[92:95], v[84:87], v[44:47]
  v_mfma_f32_16x16x32_bf16 v[40:43], v[92:95], v[80:83], v[40:43]
  v_mfma_f32_16x16x32_bf16 v[36:39], v[92:95], v[76:79], v[36:39]
  v_mfma_f32_16x16x32_bf16 v[32:35], v[92:95], v[72:75], v[32:35]
  v_mfma_f32_16x16x32_bf16 v[28:31], v[92:95], v[68:71], v[28:31]
  ds_read_b128 v[68:71], v7 offset:11264
  ds_read_b128 v[72:75], v5 offset:45056
  ds_read_b128 v[76:79], v5 offset:45312
  ds_read_b128 v[80:83], v5 offset:45568
  ds_read_b128 v[84:87], v5 offset:45824
  s_waitcnt vmcnt(14) lgkmcnt(5)
  v_mfma_f32_16x16x32_bf16 v[8:11], v[96:99], v[48:51], v[8:11]
  v_mfma_f32_16x16x32_bf16 v[12:15], v[96:99], v[52:55], v[12:15]
  v_mfma_f32_16x16x32_bf16 v[16:19], v[96:99], v[56:59], v[16:19]
  v_mfma_f32_16x16x32_bf16 v[20:23], v[96:99], v[60:63], v[20:23]
  v_mfma_f32_16x16x32_bf16 v[24:27], v[96:99], v[64:67], v[24:27]
  v_mfma_f32_16x16x32_bf16 v[44:47], v[100:103], v[64:67], v[44:47]
  v_mfma_f32_16x16x32_bf16 v[40:43], v[100:103], v[60:63], v[40:43]
  v_mfma_f32_16x16x32_bf16 v[36:39], v[100:103], v[56:59], v[36:39]
  v_mfma_f32_16x16x32_bf16 v[32:35], v[100:103], v[52:55], v[32:35]
  v_mfma_f32_16x16x32_bf16 v[28:31], v[100:103], v[48:51], v[28:31]
  s_waitcnt vmcnt(12) lgkmcnt(0)
  v_mfma_f32_16x16x32_bf16 v[8:11], v[104:107], v[68:71], v[8:11]
  v_mfma_f32_16x16x32_bf16 v[12:15], v[104:107], v[72:75], v[12:15]
  v_mfma_f32_16x16x32_bf16 v[16:19], v[104:107], v[76:79], v[16:19]
  v_mfma_f32_16x16x32_bf16 v[20:23], v[104:107], v[80:83], v[20:23]
  v_mfma_f32_16x16x32_bf16 v[24:27], v[104:107], v[84:87], v[24:27]
  v_mfma_f32_16x16x32_bf16 v[44:47], v[108:111], v[84:87], v[44:47]
  v_mfma_f32_16x16x32_bf16 v[40:43], v[108:111], v[80:83], v[40:43]
  v_mfma_f32_16x16x32_bf16 v[36:39], v[108:111], v[76:79], v[36:39]
  v_mfma_f32_16x16x32_bf16 v[32:35], v[108:111], v[72:75], v[32:35]
  v_mfma_f32_16x16x32_bf16 v[28:31], v[108:111], v[68:71], v[28:31]
  s_add_u32 s36, s27, 104
  v_mov_b32 v160, s36
L_lw_10:
  ds_read_b32 v161, v160
  s_waitcnt lgkmcnt(0)
  v_readfirstlane_b32 s36, v161
  s_nop 3
  s_cmp_ge_u32 s36, 4
  s_cbranch_scc1 L_lw_10_ok
  s_sleep 2
  s_branch L_lw_10
L_lw_10_ok:
  ds_read_b128 v[48:51], v7 offset:12288
  ds_read_b128 v[52:55], v6 offset:0
  ds_read_b128 v[56:59], v6 offset:256
  ds_read_b128 v[60:63], v6 offset:512
  ds_read_b128 v[64:67], v6 offset:768
  ds_read_b128 v[68:71], v7 offset:13312
  ds_read_b128 v[72:75], v6 offset:4096
  ds_read_b128 v[76:79], v6 offset:4352
  ds_read_b128 v[80:83], v6 offset:4608
  ds_read_b128 v[84:87], v6 offset:4864
  s_waitcnt vmcnt(10) lgkmcnt(5)
  v_mfma_f32_16x16x32_bf16 v[8:11], v[112:115], v[48:51], v[8:11]
  v_mfma_f32_16x16x32_bf16 v[12:15], v[112:115], v[52:55], v[12:15]
  v_mfma_f32_16x16x32_bf16 v[16:19], v[112:115], v[56:59], v[16:19]
  v_mfma_f32_16x16x32_bf16 v[20:23], v[112:115], v[60:63], v[20:23]
  v_mfma_f32_16x16x32_bf16 v[24:27], v[112:115], v[64:67], v[24:27]
  v_mfma_f32_16x16x32_bf16 v[44:47], v[116:119], v[64:67], v[44:47]
  v_mfma_f32_16x16x32_bf16 v[40:43], v[116:119], v[60:63], v[40:43]
  v_mfma_f32_16x16x32_bf16 v[36:39], v[116:119], v[56:59], v[36:39]
  v_mfma_f32_16x16x32_bf16 v[32:35], v[116:119], v[52:55], v[32:35]
  v_mfma_f32_16x16x32_bf16 v[28:31], v[116:119], v[48:51], v[28:31]
  ds_read_b128 v[48:51], v7 offset:14336
  ds_read_b128 v[52:55], v6 offset:8192
  ds_read_b128 v[56:59], v6 offset:8448
  ds_read_b128 v[60:63], v6 offset:8704
  ds_read_b128 v[64:67], v6 offset:8960
  s_waitcnt vmcnt(8) lgkmcnt(5)
  v_mfma_f32_16x16x32_bf16 v[8:11], v[120:123], v[68:71], v[8:11]
  v_mfma_f32_16x16x32_bf16 v[12:15], v[120:123], v[72:75], v[12:15]
  v_mfma_f32_16x16x32_bf16 v[16:19], v[120:123], v[76:79], v[16:19]
  v_mfma_f32_16x16x32_bf16 v[20:23], v[120:123], v[80:83], v[20:23]
  v_mfma_f32_16x16x32_bf16 v[24:27], v[120:123], v[84:87], v[24:27]
  v_mfma_f32_16x16x32_bf16 v[44:47], v[124:127], v[84:87], v[44:47]
  v_mfma_f32_16x16x32_bf16 v[40:43], v[124:127], v[80:83], v[40:43]
  v_mfma_f32_16x16x32_bf16 v[36:39], v[124:127], v[76:79], v[36:39]
  v_mfma_f32_16x16x32_bf16 v[32:35], v[124:127], v[72:75], v[32:35]
  v_mfma_f32_16x16x32_bf16 v[28:31], v[124:127], v[68:71], v[28:31]
  buffer_load_dwordx4 v[124:127], v2, s[8:11], s58 offen offset:0 sc1
  ds_read_b128 v[68:71], v7 offset:15360
  ds_read_b128 v[72:75], v6 offset:12288
  ds_read_b128 v[76:79], v6 offset:12544
  ds_read_b128 v[80:83], v6 offset:12800
  ds_read_b128 v[84:87], v6 offset:13056
  s_waitcnt vmcnt(7) lgkmcnt(5)
  v_mfma_f32_16x16x32_bf16 v[8:11], v[128:131], v[48:51], v[8:11]
  v_mfma_f32_16x16x32_bf16 v[12:15], v[128:131], v[52:55], v[12:15]
  v_mfma_f32_16x16x32_bf16 v[16:19], v[128:131], v[56:59], v[16:19]
  v_mfma_f32_16x16x32_bf16 v[20:23], v[128:131], v[60:63], v[20:23]
  v_mfma_f32_16x16x32_bf16 v[24:27], v[128:131], v[64:67], v[24:27]
  v_mfma_f32_16x16x32_bf16 v[44:47], v[132:135], v[64:67], v[44:47]
  v_mfma_f32_16x16x32_bf16 v[40:43], v[132:135], v[60:63], v[40:43]
  v_mfma_f32_16x16x32_bf16 v[36:39], v[132:135], v[56:59], v[36:39]
  v_mfma_f32_16x16x32_bf16 v[32:35], v[132:135], v[52:55], v[32:35]
  v_mfma_f32_16x16x32_bf16 v[28:31], v[132:135], v[48:51], v[28:31]
  buffer_load_dwordx4 v[128:131], v2, s[8:11], s58 offen offset:1024 sc1
  buffer_load_dwordx4 v[132:135], v2, s[8:11], s58 offen offset:2048 sc1
  ds_read_b128 v[48:51], v7 offset:16384
  ds_read_b128 v[52:55], v6 offset:16384
  ds_read_b128 v[56:59], v6 offset:16640
  ds_read_b128 v[60:63], v6 offset:16896
  ds_read_b128 v[64:67], v6 offset:17152
  s_waitcnt vmcnt(7) lgkmcnt(5)
  v_mfma_f32_16x16x32_bf16 v[8:11], v[136:139], v[68:71], v[8:11]
  v_mfma_f32_16x16x32_bf16 v[12:15], v[136:139], v[72:75], v[12:15]
  v_mfma_f32_16x16x32_bf16 v[16:19], v[136:139], v[76:79], v[16:19]
  v_mfma_f32_16x16x32_bf16 v[20:23], v[136:139], v[80:83], v[20:23]
  v_mfma_f32_16x16x32_bf16 v[24:27], v[136:139], v[84:87], v[24:27]
  v_mfma_f32_16x16x32_bf16 v[44:47], v[140:143], v[84:87], v[44:47]
  v_mfma_f32_16x16x32_bf16 v[40:43], v[140:143], v[80:83], v[40:43]
  v_mfma_f32_16x16x32_bf16 v[36:39], v[140:143], v[76:79], v[36:39]
  v_mfma_f32_16x16x32_bf16 v[32:35], v[140:143], v[72:75], v[32:35]
  v_mfma_f32_16x16x32_bf16 v[28:31], v[140:143], v[68:71], v[28:31]
  buffer_load_dwordx4 v[136:139], v2, s[8:11], s58 offen offset:3072 sc1
  s_add_u32 s58, s58, 4096
  buffer_load_dwordx4 v[140:143], v2, s[8:11], s58 offen offset:0 sc1
  ds_read_b128 v[68:71], v7 offset:17408
  ds_read_b128 v[72:75], v6 offset:20480
  ds_read_b128 v[76:79], v6 offset:20736
  ds_read_b128 v[80:83], v6 offset:20992
  ds_read_b128 v[84:87], v6 offset:21248
  s_waitcnt vmcnt(7) lgkmcnt(5)
  v_mfma_f32_16x16x32_bf16 v[8:11], v[144:147], v[48:51], v[8:11]
  v_mfma_f32_16x16x32_bf16 v[12:15], v[144:147], v[52:55], v[12:15]
  v_mfma_f32_16x16x32_bf16 v[16:19], v[144:147], v[56:59], v[16:19]
  v_mfma_f32_16x16x32_bf16 v[20:23], v[144:147], v[60:63], v[20:23]
  v_mfma_f32_16x16x32_bf16 v[24:27], v[144:147], v[64:67], v[24:27]
  v_mfma_f32_16x16x32_bf16 v[44:47], v[148:151], v[64:67], v[44:47]
  v_mfma_f32_16x16x32_bf16 v[40:43], v[148:151], v[60:63], v[40:43]
  v_mfma_f32_16x16x32_bf16 v[36:39], v[148:151], v[56:59], v[36:39]
  v_mfma_f32_16x16x32_bf16 v[32:35], v[148:151], v[52:55], v[32:35]
  v_mfma_f32_16x16x32_bf16 v[28:31], v[148:151], v[48:51], v[28:31]
  buffer_load_dwordx4 v[144:147], v2, s[8:11], s58 offen offset:1024 sc1
  buffer_load_dwordx4 v[148:151], v2, s[8:11], s58 offen offset:2048 sc1
  s_waitcnt vmcnt(7) lgkmcnt(0)
  v_mfma_f32_16x16x32_bf16 v[8:11], v[152:155], v[68:71], v[8:11]
  v_mfma_f32_16x16x32_bf16 v[12:15], v[152:155], v[72:75], v[12:15]
  v_mfma_f32_16x16x32_bf16 v[16:19], v[152:155], v[76:79], v[16:19]
  v_mfma_f32_16x16x32_bf16 v[20:23], v[152:155], v[80:83], v[20:23]
  v_mfma_f32_16x16x32_bf16 v[24:27], v[152:155], v[84:87], v[24:27]
  v_mfma_f32_16x16x32_bf16 v[44:47], v[156:159], v[84:87], v[44:47]
  v_mfma_f32_16x16x32_bf16 v[40:43], v[156:159], v[80:83], v[40:43]
  v_mfma_f32_16x16x32_bf16 v[36:39], v[156:159], v[76:79], v[36:39]
  v_mfma_f32_16x16x32_bf16 v[32:35], v[156:159], v[72:75], v[32:35]
  v_mfma_f32_16x16x32_bf16 v[28:31], v[156:159], v[68:71], v[28:31]
  buffer_load_dwordx4 v[152:155], v2, s[8:11], s58 offen offset:3072 sc1
  s_add_u32 s58, s58, 4096
  buffer_load_dwordx4 v[156:159], v2, s[8:11], s58 offen offset:0 sc1
  s_add_u32 s36, s27, 0
  v_mov_b32 v48, s36
L_lw_11:
  ds_read_b32 v49, v48
  s_waitcnt lgkmcnt(0)
  v_readfirstlane_b32 s36, v49
  s_nop 3
  s_cmp_ge_u32 s36, 3
  s_cbranch_scc1 L_lw_11_ok
  s_sleep 2
  s_branch L_lw_11
L_lw_11_ok:
  v_lshlrev_b32 v53, 3, v4
  v_add_u32 v53, 151040, v53
  ds_read_b64 v[54:55], v53 offset:0
  ds_read_b64 v[56:57], v53 offset:128
  ds_read_b64 v[58:59], v53 offset:256
  ds_read_b64 v[60:61], v53 offset:384
  ds_read_b64 v[62:63], v53 offset:512
  s_cmp_lt_u32 s3, 2
  s_cbranch_scc1 L_A_vpair
  v_lshlrev_b32 v50, 2, v3
  s_add_u32 s36, s40, 0
  s_lshl_b32 s36, s36, 4
  v_add_u32 v50, s36, v50
  s_mov_b32 s36, 160768
  v_lshl_add_u32 v53, v50, 2, s36
  ds_read_b128 v[160:163], v53
  s_mov_b32 s36, 57
  v_mul_u32_u24 v51, s36, v50
  v_lshrrev_b32 v51, 10, v51
  s_movk_i32 s36, 3932
  v_mul_u32_u24 v48, s36, v51
  v_lshl_add_u32 v48, v50, 1, v48
  v_mul_u32_u24 v52, 48, v4
  s_mov_b32 s36, 92160
  v_add3_u32 v48, v48, v52, s36
  v_add_u32 v50, 2, v50
  s_mov_b32 s36, 57
  v_mul_u32_u24 v51, s36, v50
  v_lshrrev_b32 v51, 10, v51
  s_movk_i32 s36, 3932
  v_mul_u32_u24 v49, s36, v51
  v_lshl_add_u32 v49, v50, 1, v49
  v_mul_u32_u24 v52, 48, v4
  s_mov_b32 s36, 92160
  v_add3_u32 v49, v49, v52, s36
  s_waitcnt lgkmcnt(0)
  v_mul_f32 v8, v8, v54
  v_fmac_f32 v8, v55, v160
  v_mul_f32 v9, v9, v54
  v_fmac_f32 v9, v55, v161
  v_mul_f32 v10, v10, v54
  v_fmac_f32 v10, v55, v162
  v_mul_f32 v11, v11, v54
  v_fmac_f32 v11, v55, v163
  v_cvt_pk_bf16_f32 v8, v8, v9
  v_cvt_pk_bf16_f32 v9, v10, v11
  ds_write_b32 v48, v8 offset:0
  ds_write_b32 v49, v9 offset:0
  v_mul_f32 v12, v12, v56
  v_fmac_f32 v12, v57, v160
  v_mul_f32 v13, v13, v56
  v_fmac_f32 v13, v57, v161
  v_mul_f32 v14, v14, v56
  v_fmac_f32 v14, v57, v162
  v_mul_f32 v15, v15, v56
  v_fmac_f32 v15, v57, v163
  v_cvt_pk_bf16_f32 v12, v12, v13
  v_cvt_pk_bf16_f32 v13, v14, v15
  ds_write_b32 v48, v12 offset:768
  ds_write_b32 v49, v13 offset:768
  v_mul_f32 v16, v16, v58
  v_fmac_f32 v16, v59, v160
  v_mul_f32 v17, v17, v58
  v_fmac_f32 v17, v59, v161
  v_mul_f32 v18, v18, v58
  v_fmac_f32 v18, v59, v162
  v_mul_f32 v19, v19, v58
  v_fmac_f32 v19, v59, v163
  v_cvt_pk_bf16_f32 v16, v16, v17
  v_cvt_pk_bf16_f32 v17, v18, v19
  ds_write_b32 v48, v16 offset:1536
  ds_write_b32 v49, v17 offset:1536
  v_mul_f32 v20, v20, v60
  v_fmac_f32 v20, v61, v160
  v_mul_f32 v21, v21, v60
  v_fmac_f32 v21, v61, v161
  v_mul_f32 v22, v22, v60
  v_fmac_f32 v22, v61, v162
  v_mul_f32 v23, v23, v60
  v_fmac_f32 v23, v61, v163
  v_cvt_pk_bf16_f32 v20, v20, v21
  v_cvt_pk_bf16_f32 v21, v22, v23
  ds_write_b32 v48, v20 offset:2304
  ds_write_b32 v49, v21 offset:2304
  v_mul_f32 v24, v24, v62
  v_fmac_f32 v24, v63, v160
  v_mul_f32 v25, v25, v62
  v_fmac_f32 v25, v63, v161
  v_mul_f32 v26, v26, v62
  v_fmac_f32 v26, v63, v162
  v_mul_f32 v27, v27, v62
  v_fmac_f32 v27, v63, v163
  v_cvt_pk_bf16_f32 v24, v24, v25
  v_cvt_pk_bf16_f32 v25, v26, v27
  ds_write_b32 v48, v24 offset:3072
  ds_write_b32 v49, v25 offset:3072
  v_lshlrev_b32 v50, 2, v3
  s_add_u32 s36, s40, 1
  s_lshl_b32 s36, s36, 4
  v_add_u32 v50, s36, v50
  s_mov_b32 s36, 160768
  v_lshl_add_u32 v53, v50, 2, s36
  ds_read_b128 v[164:167], v53
  s_mov_b32 s36, 57
  v_mul_u32_u24 v51, s36, v50
  v_lshrrev_b32 v51, 10, v51
  s_movk_i32 s36, 3932
  v_mul_u32_u24 v48, s36, v51
  v_lshl_add_u32 v48, v50, 1, v48
  v_mul_u32_u24 v52, 48, v4
  s_mov_b32 s36, 92160
  v_add3_u32 v48, v48, v52, s36
  v_add_u32 v50, 2, v50
  s_mov_b32 s36, 57
  v_mul_u32_u24 v51, s36, v50
  v_lshrrev_b32 v51, 10, v51
  s_movk_i32 s36, 3932
  v_mul_u32_u24 v49, s36, v51
  v_lshl_add_u32 v49, v50, 1, v49
  v_mul_u32_u24 v52, 48, v4
  s_mov_b32 s36, 92160
  v_add3_u32 v49, v49, v52, s36
  s_waitcnt lgkmcnt(0)
  v_mul_f32 v28, v28, v54
  v_fmac_f32 v28, v55, v164
  v_mul_f32 v29, v29, v54
  v_fmac_f32 v29, v55, v165
  v_mul_f32 v30, v30, v54
  v_fmac_f32 v30, v55, v166
  v_mul_f32 v31, v31, v54
  v_fmac_f32 v31, v55, v167
  v_cvt_pk_bf16_f32 v28, v28, v29
  v_cvt_pk_bf16_f32 v29, v30, v31
  ds_write_b32 v48, v28 offset:0
  ds_write_b32 v49, v29 offset:0
  v_mul_f32 v32, v32, v56
  v_fmac_f32 v32, v57, v164
  v_mul_f32 v33, v33, v56
  v_fmac_f32 v33, v57, v165
  v_mul_f32 v34, v34, v56
  v_fmac_f32 v34, v57, v166
  v_mul_f32 v35, v35, v56
  v_fmac_f32 v35, v57, v167
  v_cvt_pk_bf16_f32 v32, v32, v33
  v_cvt_pk_bf16_f32 v33, v34, v35
  ds_write_b32 v48, v32 offset:768
  ds_write_b32 v49, v33 offset:768
  v_mul_f32 v36, v36, v58
  v_fmac_f32 v36, v59, v164
  v_mul_f32 v37, v37, v58
  v_fmac_f32 v37, v59, v165
  v_mul_f32 v38, v38, v58
  v_fmac_f32 v38, v59, v166
  v_mul_f32 v39, v39, v58
  v_fmac_f32 v39, v59, v167
  v_cvt_pk_bf16_f32 v36, v36, v37
  v_cvt_pk_bf16_f32 v37, v38, v39
  ds_write_b32 v48, v36 offset:1536
  ds_write_b32 v49, v37 offset:1536
  v_mul_f32 v40, v40, v60
  v_fmac_f32 v40, v61, v164
  v_mul_f32 v41, v41, v60
  v_fmac_f32 v41, v61, v165
  v_mul_f32 v42, v42, v60
  v_fmac_f32 v42, v61, v166
  v_mul_f32 v43, v43, v60
  v_fmac_f32 v43, v61, v167
  v_cvt_pk_bf16_f32 v40, v40, v41
  v_cvt_pk_bf16_f32 v41, v42, v43
  ds_write_b32 v48, v40 offset:2304
  ds_write_b32 v49, v41 offset:2304
  v_mul_f32 v44, v44, v62
  v_fmac_f32 v44, v63, v164
  v_mul_f32 v45, v45, v62
  v_fmac_f32 v45, v63, v165
  v_mul_f32 v46, v46, v62
  v_fmac_f32 v46, v63, v166
  v_mul_f32 v47, v47, v62
  v_fmac_f32 v47, v63, v167
  v_cvt_pk_bf16_f32 v44, v44, v45
  v_cvt_pk_bf16_f32 v45, v46, v47
  ds_write_b32 v48, v44 offset:3072
  ds_write_b32 v49, v45 offset:3072
  s_branch L_A_att
L_A_vpair:
  v_lshlrev_b32 v50, 2, v3
  s_add_u32 s36, s40, 0
  s_lshl_b32 s36, s36, 4
  v_add_u32 v50, s36, v50
  s_mov_b32 s36, 160768
  v_lshl_add_u32 v53, v50, 2, s36
  ds_read_b128 v[160:163], v53
  s_mov_b32 s36, 57
  v_mul_u32_u24 v51, s36, v50
  v_lshrrev_b32 v51, 10, v51
  s_movk_i32 s36, 6712
  v_mul_u32_u24 v48, s36, v51
  v_lshl_add_u32 v48, v50, 2, v48
  v_mul_u32_u24 v52, 0x50, v4
  s_mov_b32 s36, 69632
  v_add3_u32 v48, v48, v52, s36
  v_add_u32 v50, 2, v50
  s_mov_b32 s36, 57
  v_mul_u32_u24 v51, s36, v50
  v_lshrrev_b32 v51, 10, v51
  s_movk_i32 s36, 6712
  v_mul_u32_u24 v49, s36, v51
  v_lshl_add_u32 v49, v50, 2, v49
  v_mul_u32_u24 v52, 0x50, v4
  s_mov_b32 s36, 69632
  v_add3_u32 v49, v49, v52, s36
  s_mov_b32 s36, 0x05040100
  s_mov_b32 s37, 0x07060302
  s_waitcnt lgkmcnt(0)
  v_mul_f32 v8, v8, v54
  v_fmac_f32 v8, v55, v160
  v_mul_f32 v9, v9, v54
  v_fmac_f32 v9, v55, v161
  v_mul_f32 v10, v10, v54
  v_fmac_f32 v10, v55, v162
  v_mul_f32 v11, v11, v54
  v_fmac_f32 v11, v55, v163
  v_cvt_pk_bf16_f32 v8, v8, v9
  v_cvt_pk_bf16_f32 v9, v10, v11
  v_mul_f32 v12, v12, v56
  v_fmac_f32 v12, v57, v160
  v_mul_f32 v13, v13, v56
  v_fmac_f32 v13, v57, v161
  v_mul_f32 v14, v14, v56
  v_fmac_f32 v14, v57, v162
  v_mul_f32 v15, v15, v56
  v_fmac_f32 v15, v57, v163
  v_cvt_pk_bf16_f32 v12, v12, v13
  v_cvt_pk_bf16_f32 v13, v14, v15
  v_mul_f32 v16, v16, v58
  v_fmac_f32 v16, v59, v160
  v_mul_f32 v17, v17, v58
  v_fmac_f32 v17, v59, v161
  v_mul_f32 v18, v18, v58
  v_fmac_f32 v18, v59, v162
  v_mul_f32 v19, v19, v58
  v_fmac_f32 v19, v59, v163
  v_cvt_pk_bf16_f32 v16, v16, v17
  v_cvt_pk_bf16_f32 v17, v18, v19
  v_mul_f32 v20, v20, v60
  v_fmac_f32 v20, v61, v160
  v_mul_f32 v21, v21, v60
  v_fmac_f32 v21, v61, v161
  v_mul_f32 v22, v22, v60
  v_fmac_f32 v22, v61, v162
  v_mul_f32 v23, v23, v60
  v_fmac_f32 v23, v61, v163
  v_cvt_pk_bf16_f32 v20, v20, v21
  v_cvt_pk_bf16_f32 v21, v22, v23
  v_mul_f32 v24, v24, v62
  v_fmac_f32 v24, v63, v160
  v_mul_f32 v25, v25, v62
  v_fmac_f32 v25, v63, v161
  v_mul_f32 v26, v26, v62
  v_fmac_f32 v26, v63, v162
  v_mul_f32 v27, v27, v62
  v_fmac_f32 v27, v63, v163
  v_cvt_pk_bf16_f32 v24, v24, v25
  v_cvt_pk_bf16_f32 v25, v26, v27
  v_mov_b32_dpp v10, v8 row_shr:2 row_mask:0xf bank_mask:0xf
  v_mov_b32_dpp v11, v9 row_shr:2 row_mask:0xf bank_mask:0xf
  v_perm_b32 v64, v10, v8, s36
  v_perm_b32 v65, v10, v8, s37
  v_perm_b32 v66, v11, v9, s36
  v_perm_b32 v67, v11, v9, s37
  ds_write_b64 v48, v[64:65] offset:0
  ds_write_b64 v49, v[66:67] offset:0
  v_mov_b32_dpp v14, v8 row_shl:14 row_mask:0xf bank_mask:0xf
  v_mov_b32_dpp v15, v9 row_shl:14 row_mask:0xf bank_mask:0xf
  v_mov_b32_dpp v14, v12 row_shr:2 row_mask:0xf bank_mask:0xf
  v_mov_b32_dpp v15, v13 row_shr:2 row_mask:0xf bank_mask:0xf
  v_perm_b32 v68, v14, v12, s36
  v_perm_b32 v69, v14, v12, s37
  v_perm_b32 v70, v15, v13, s36
  v_perm_b32 v71, v15, v13, s37
  ds_write_b64 v48, v[68:69] offset:1280
  ds_write_b64 v49, v[70:71] offset:1280
  v_mov_b32_dpp v18, v12 row_shl:14 row_mask:0xf bank_mask:0xf
  v_mov_b32_dpp v19, v13 row_shl:14 row_mask:0xf bank_mask:0xf
  v_mov_b32_dpp v18, v16 row_shr:2 row_mask:0xf bank_mask:0xf
  v_mov_b32_dpp v19, v17 row_shr:2 row_mask:0xf bank_mask:0xf
  v_perm_b32 v64, v18, v16, s36
  v_perm_b32 v65, v18, v16, s37
  v_perm_b32 v66, v19, v17, s36
  v_perm_b32 v67, v19, v17, s37
  ds_write_b64 v48, v[64:65] offset:2560
  ds_write_b64 v49, v[66:67] offset:2560
  v_mov_b32_dpp v22, v16 row_shl:14 row_mask:0xf bank_mask:0xf
  v_mov_b32_dpp v23, v17 row_shl:14 row_mask:0xf bank_mask:0xf
  v_mov_b32_dpp v22, v20 row_shr:2 row_mask:0xf bank_mask:0xf
  v_mov_b32_dpp v23, v21 row_shr:2 row_mask:0xf bank_mask:0xf
  v_perm_b32 v68, v22, v20, s36
  v_perm_b32 v69, v22, v20, s37
  v_perm_b32 v70, v23, v21, s36
  v_perm_b32 v71, v23, v21, s37
  ds_write_b64 v48, v[68:69] offset:3840
  ds_write_b64 v49, v[70:71] offset:3840
  v_mov_b32_dpp v26, v20 row_shl:14 row_mask:0xf bank_mask:0xf
  v_mov_b32_dpp v27, v21 row_shl:14 row_mask:0xf bank_mask:0xf
  v_mov_b32_dpp v26, v24 row_shr:2 row_mask:0xf bank_mask:0xf
  v_mov_b32_dpp v27, v25 row_shr:2 row_mask:0xf bank_mask:0xf
  v_perm_b32 v64, v26, v24, s36
  v_perm_b32 v65, v26, v24, s37
  v_perm_b32 v66, v27, v25, s36
  v_perm_b32 v67, v27, v25, s37
  ds_write_b64 v48, v[64:65] offset:5120
  ds_write_b64 v49, v[66:67] offset:5120
  v_lshlrev_b32 v50, 2, v3
  s_add_u32 s36, s40, 1
  s_lshl_b32 s36, s36, 4
  v_add_u32 v50, s36, v50
  s_mov_b32 s36, 160768
  v_lshl_add_u32 v53, v50, 2, s36
  ds_read_b128 v[164:167], v53
  s_mov_b32 s36, 57
  v_mul_u32_u24 v51, s36, v50
  v_lshrrev_b32 v51, 10, v51
  s_movk_i32 s36, 6712
  v_mul_u32_u24 v48, s36, v51
  v_lshl_add_u32 v48, v50, 2, v48
  v_mul_u32_u24 v52, 0x50, v4
  s_mov_b32 s36, 69632
  v_add3_u32 v48, v48, v52, s36
  v_add_u32 v50, 2, v50
  s_mov_b32 s36, 57
  v_mul_u32_u24 v51, s36, v50
  v_lshrrev_b32 v51, 10, v51
  s_movk_i32 s36, 6712
  v_mul_u32_u24 v49, s36, v51
  v_lshl_add_u32 v49, v50, 2, v49
  v_mul_u32_u24 v52, 0x50, v4
  s_mov_b32 s36, 69632
  v_add3_u32 v49, v49, v52, s36
  s_mov_b32 s36, 0x05040100
  s_mov_b32 s37, 0x07060302
  s_waitcnt lgkmcnt(0)
  v_mul_f32 v28, v28, v54
  v_fmac_f32 v28, v55, v164
  v_mul_f32 v29, v29, v54
  v_fmac_f32 v29, v55, v165
  v_mul_f32 v30, v30, v54
  v_fmac_f32 v30, v55, v166
  v_mul_f32 v31, v31, v54
  v_fmac_f32 v31, v55, v167
  v_cvt_pk_bf16_f32 v28, v28, v29
  v_cvt_pk_bf16_f32 v29, v30, v31
  v_mul_f32 v32, v32, v56
  v_fmac_f32 v32, v57, v164
  v_mul_f32 v33, v33, v56
  v_fmac_f32 v33, v57, v165
  v_mul_f32 v34, v34, v56
  v_fmac_f32 v34, v57, v166
  v_mul_f32 v35, v35, v56
  v_fmac_f32 v35, v57, v167
  v_cvt_pk_bf16_f32 v32, v32, v33
  v_cvt_pk_bf16_f32 v33, v34, v35
  v_mul_f32 v36, v36, v58
  v_fmac_f32 v36, v59, v164
  v_mul_f32 v37, v37, v58
  v_fmac_f32 v37, v59, v165
  v_mul_f32 v38, v38, v58
  v_fmac_f32 v38, v59, v166
  v_mul_f32 v39, v39, v58
  v_fmac_f32 v39, v59, v167
  v_cvt_pk_bf16_f32 v36, v36, v37
  v_cvt_pk_bf16_f32 v37, v38, v39
  v_mul_f32 v40, v40, v60
  v_fmac_f32 v40, v61, v164
  v_mul_f32 v41, v41, v60
  v_fmac_f32 v41, v61, v165
  v_mul_f32 v42, v42, v60
  v_fmac_f32 v42, v61, v166
  v_mul_f32 v43, v43, v60
  v_fmac_f32 v43, v61, v167
  v_cvt_pk_bf16_f32 v40, v40, v41
  v_cvt_pk_bf16_f32 v41, v42, v43
  v_mul_f32 v44, v44, v62
  v_fmac_f32 v44, v63, v164
  v_mul_f32 v45, v45, v62
  v_fmac_f32 v45, v63, v165
  v_mul_f32 v46, v46, v62
  v_fmac_f32 v46, v63, v166
  v_mul_f32 v47, v47, v62
  v_fmac_f32 v47, v63, v167
  v_cvt_pk_bf16_f32 v44, v44, v45
  v_cvt_pk_bf16_f32 v45, v46, v47
  v_mov_b32_dpp v30, v28 row_shr:2 row_mask:0xf bank_mask:0xf
  v_mov_b32_dpp v31, v29 row_shr:2 row_mask:0xf bank_mask:0xf
  v_perm_b32 v64, v30, v28, s36
  v_perm_b32 v65, v30, v28, s37
  v_perm_b32 v66, v31, v29, s36
  v_perm_b32 v67, v31, v29, s37
  ds_write_b64 v48, v[64:65] offset:0
  ds_write_b64 v49, v[66:67] offset:0
  v_mov_b32_dpp v34, v28 row_shl:14 row_mask:0xf bank_mask:0xf
  v_mov_b32_dpp v35, v29 row_shl:14 row_mask:0xf bank_mask:0xf
  v_mov_b32_dpp v34, v32 row_shr:2 row_mask:0xf bank_mask:0xf
  v_mov_b32_dpp v35, v33 row_shr:2 row_mask:0xf bank_mask:0xf
  v_perm_b32 v68, v34, v32, s36
  v_perm_b32 v69, v34, v32, s37
  v_perm_b32 v70, v35, v33, s36
  v_perm_b32 v71, v35, v33, s37
  ds_write_b64 v48, v[68:69] offset:1280
  ds_write_b64 v49, v[70:71] offset:1280
  v_mov_b32_dpp v38, v32 row_shl:14 row_mask:0xf bank_mask:0xf
  v_mov_b32_dpp v39, v33 row_shl:14 row_mask:0xf bank_mask:0xf
  v_mov_b32_dpp v38, v36 row_shr:2 row_mask:0xf bank_mask:0xf
  v_mov_b32_dpp v39, v37 row_shr:2 row_mask:0xf bank_mask:0xf
  v_perm_b32 v64, v38, v36, s36
  v_perm_b32 v65, v38, v36, s37
  v_perm_b32 v66, v39, v37, s36
  v_perm_b32 v67, v39, v37, s37
  ds_write_b64 v48, v[64:65] offset:2560
  ds_write_b64 v49, v[66:67] offset:2560
  v_mov_b32_dpp v42, v36 row_shl:14 row_mask:0xf bank_mask:0xf
  v_mov_b32_dpp v43, v37 row_shl:14 row_mask:0xf bank_mask:0xf
  v_mov_b32_dpp v42, v40 row_shr:2 row_mask:0xf bank_mask:0xf
  v_mov_b32_dpp v43, v41 row_shr:2 row_mask:0xf bank_mask:0xf
  v_perm_b32 v68, v42, v40, s36
  v_perm_b32 v69, v42, v40, s37
  v_perm_b32 v70, v43, v41, s36
  v_perm_b32 v71, v43, v41, s37
  ds_write_b64 v48, v[68:69] offset:3840
  ds_write_b64 v49, v[70:71] offset:3840
  v_mov_b32_dpp v46, v40 row_shl:14 row_mask:0xf bank_mask:0xf
  v_mov_b32_dpp v47, v41 row_shl:14 row_mask:0xf bank_mask:0xf
  v_mov_b32_dpp v46, v44 row_shr:2 row_mask:0xf bank_mask:0xf
  v_mov_b32_dpp v47, v45 row_shr:2 row_mask:0xf bank_mask:0xf
  v_perm_b32 v64, v46, v44, s36
  v_perm_b32 v65, v46, v44, s37
  v_perm_b32 v66, v47, v45, s36
  v_perm_b32 v67, v47, v45, s37
  ds_write_b64 v48, v[64:65] offset:5120
  ds_write_b64 v49, v[66:67] offset:5120
  s_branch L_A_att
L_A_qpair:
  s_add_u32 s43, s41, 0
  s_add_u32 s44, s41, 18432
  buffer_load_dwordx4 v[88:91], v2, s[8:11], s43 offen sc1
  buffer_load_dwordx4 v[92:95], v2, s[8:11], s44 offen sc1
  s_add_u32 s43, s41, 1024
  s_add_u32 s44, s41, 19456
  buffer_load_dwordx4 v[96:99], v2, s[8:11], s43 offen sc1
  buffer_load_dwordx4 v[100:103], v2, s[8:11], s44 offen sc1
  s_add_u32 s43, s41, 2048
  s_add_u32 s44, s41, 20480
  buffer_load_dwordx4 v[104:107], v2, s[8:11], s43 offen sc1
  buffer_load_dwordx4 v[108:111], v2, s[8:11], s44 offen sc1
  s_add_u32 s43, s41, 3072
  s_add_u32 s44, s41, 21504
  buffer_load_dwordx4 v[112:115], v2, s[8:11], s43 offen sc1
  buffer_load_dwordx4 v[116:119], v2, s[8:11], s44 offen sc1
  s_add_u32 s43, s41, 4096
  s_add_u32 s44, s41, 22528
  buffer_load_dwordx4 v[120:123], v2, s[8:11], s43 offen sc1
  buffer_load_dwordx4 v[124:127], v2, s[8:11], s44 offen sc1
  s_add_u32 s36, s27, 96
  v_mov_b32 v160, s36
L_lw_12:
  ds_read_b32 v161, v160
  s_waitcnt lgkmcnt(0)
  v_readfirstlane_b32 s36, v161
  s_nop 3
  s_cmp_ge_u32 s36, 4
  s_cbranch_scc1 L_lw_12_ok
  s_sleep 2
  s_branch L_lw_12
L_lw_12_ok:
  ds_read_b128 v[40:43], v5 offset:0
  ds_read_b128 v[44:47], v5 offset:256
  ds_read_b128 v[48:51], v5 offset:512
  ds_read_b128 v[52:55], v5 offset:768
  ds_read_b128 v[56:59], v5 offset:4096
  ds_read_b128 v[60:63], v5 offset:4352
  ds_read_b128 v[64:67], v5 offset:4608
  ds_read_b128 v[68:71], v5 offset:4864
  ds_read_b128 v[72:75], v5 offset:8192
  ds_read_b128 v[76:79], v5 offset:8448
  ds_read_b128 v[80:83], v5 offset:8704
  ds_read_b128 v[84:87], v5 offset:8960
  s_waitcnt vmcnt(8) lgkmcnt(8)
  v_mfma_f32_16x16x32_bf16 v[8:11], v[88:91], v[40:43], 0
  v_mfma_f32_16x16x32_bf16 v[12:15], v[88:91], v[44:47], 0
  v_mfma_f32_16x16x32_bf16 v[16:19], v[88:91], v[48:51], 0
  v_mfma_f32_16x16x32_bf16 v[20:23], v[88:91], v[52:55], 0
  v_mfma_f32_16x16x32_bf16 v[36:39], v[92:95], v[52:55], 0
  v_mfma_f32_16x16x32_bf16 v[32:35], v[92:95], v[48:51], 0
  v_mfma_f32_16x16x32_bf16 v[28:31], v[92:95], v[44:47], 0
  v_mfma_f32_16x16x32_bf16 v[24:27], v[92:95], v[40:43], 0
  s_add_u32 s43, s41, 5120
  s_add_u32 s44, s41, 23552
  buffer_load_dwordx4 v[128:131], v2, s[8:11], s43 offen sc1
  buffer_load_dwordx4 v[132:135], v2, s[8:11], s44 offen sc1
  ds_read_b128 v[40:43], v5 offset:12288
  ds_read_b128 v[44:47], v5 offset:12544
  ds_read_b128 v[48:51], v5 offset:12800
  ds_read_b128 v[52:55], v5 offset:13056
  s_waitcnt vmcnt(8) lgkmcnt(8)
  v_mfma_f32_16x16x32_bf16 v[8:11], v[96:99], v[56:59], v[8:11]
  v_mfma_f32_16x16x32_bf16 v[12:15], v[96:99], v[60:63], v[12:15]
  v_mfma_f32_16x16x32_bf16 v[16:19], v[96:99], v[64:67], v[16:19]
  v_mfma_f32_16x16x32_bf16 v[20:23], v[96:99], v[68:71], v[20:23]
  v_mfma_f32_16x16x32_bf16 v[36:39], v[100:103], v[68:71], v[36:39]
  v_mfma_f32_16x16x32_bf16 v[32:35], v[100:103], v[64:67], v[32:35]
  v_mfma_f32_16x16x32_bf16 v[28:31], v[100:103], v[60:63], v[28:31]
  v_mfma_f32_16x16x32_bf16 v[24:27], v[100:103], v[56:59], v[24:27]
  s_add_u32 s43, s41, 6144
  s_add_u32 s44, s41, 24576
  buffer_load_dwordx4 v[136:139], v2, s[8:11], s43 offen sc1
  buffer_load_dwordx4 v[140:143], v2, s[8:11], s44 offen sc1
  ds_read_b128 v[56:59], v5 offset:16384
  ds_read_b128 v[60:63], v5 offset:16640
  ds_read_b128 v[64:67], v5 offset:16896
  ds_read_b128 v[68:71], v5 offset:17152
  s_waitcnt vmcnt(8) lgkmcnt(8)
  v_mfma_f32_16x16x32_bf16 v[8:11], v[104:107], v[72:75], v[8:11]
  v_mfma_f32_16x16x32_bf16 v[12:15], v[104:107], v[76:79], v[12:15]
  v_mfma_f32_16x16x32_bf16 v[16:19], v[104:107], v[80:83], v[16:19]
  v_mfma_f32_16x16x32_bf16 v[20:23], v[104:107], v[84:87], v[20:23]
  v_mfma_f32_16x16x32_bf16 v[36:39], v[108:111], v[84:87], v[36:39]
  v_mfma_f32_16x16x32_bf16 v[32:35], v[108:111], v[80:83], v[32:35]
  v_mfma_f32_16x16x32_bf16 v[28:31], v[108:111], v[76:79], v[28:31]
  v_mfma_f32_16x16x32_bf16 v[24:27], v[108:111], v[72:75], v[24:27]
  s_add_u32 s43, s41, 7168
  s_add_u32 s44, s41, 25600
  buffer_load_dwordx4 v[144:147], v2, s[8:11], s43 offen sc1
  buffer_load_dwordx4 v[148:151], v2, s[8:11], s44 offen sc1
  ds_read_b128 v[72:75], v5 offset:20480
  ds_read_b128 v[76:79], v5 offset:20736
  ds_read_b128 v[80:83], v5 offset:20992
  ds_read_b128 v[84:87], v5 offset:21248
  s_waitcnt vmcnt(8) lgkmcnt(8)
  v_mfma_f32_16x16x32_bf16 v[8:11], v[112:115], v[40:43], v[8:11]
  v_mfma_f32_16x16x32_bf16 v[12:15], v[112:115], v[44:47], v[12:15]
  v_mfma_f32_16x16x32_bf16 v[16:19], v[112:115], v[48:51], v[16:19]
  v_mfma_f32_16x16x32_bf16 v[20:23], v[112:115], v[52:55], v[20:23]
  v_mfma_f32_16x16x32_bf16 v[36:39], v[116:119], v[52:55], v[36:39]
  v_mfma_f32_16x16x32_bf16 v[32:35], v[116:119], v[48:51], v[32:35]
  v_mfma_f32_16x16x32_bf16 v[28:31], v[116:119], v[44:47], v[28:31]
  v_mfma_f32_16x16x32_bf16 v[24:27], v[116:119], v[40:43], v[24:27]
  s_add_u32 s43, s41, 8192
  s_add_u32 s44, s41, 26624
  buffer_load_dwordx4 v[152:155], v2, s[8:11], s43 offen sc1
  buffer_load_dwordx4 v[156:159], v2, s[8:11], s44 offen sc1
  s_add_u32 s43, s41, 9216
  s_add_u32 s44, s41, 27648
  buffer_load_dwordx4 v[88:91], v2, s[8:11], s43 offen sc1
  buffer_load_dwordx4 v[92:95], v2, s[8:11], s44 offen sc1
  s_add_u32 s43, s41, 10240
  s_add_u32 s44, s41, 28672
  buffer_load_dwordx4 v[96:99], v2, s[8:11], s43 offen sc1
  buffer_load_dwordx4 v[100:103], v2, s[8:11], s44 offen sc1
  s_add_u32 s43, s41, 11264
  s_add_u32 s44, s41, 29696
  buffer_load_dwordx4 v[104:107], v2, s[8:11], s43 offen sc1
  buffer_load_dwordx4 v[108:111], v2, s[8:11], s44 offen sc1
  s_add_u32 s43, s41, 12288
  s_add_u32 s44, s41, 30720
  buffer_load_dwordx4 v[112:115], v2, s[8:11], s43 offen sc1
  buffer_load_dwordx4 v[116:119], v2, s[8:11], s44 offen sc1
  s_waitcnt vmcnt(16) lgkmcnt(4)
  v_mfma_f32_16x16x32_bf16 v[8:11], v[120:123], v[56:59], v[8:11]
  v_mfma_f32_16x16x32_bf16 v[12:15], v[120:123], v[60:63], v[12:15]
  v_mfma_f32_16x16x32_bf16 v[16:19], v[120:123], v[64:67], v[16:19]
  v_mfma_f32_16x16x32_bf16 v[20:23], v[120:123], v[68:71], v[20:23]
  v_mfma_f32_16x16x32_bf16 v[36:39], v[124:127], v[68:71], v[36:39]
  v_mfma_f32_16x16x32_bf16 v[32:35], v[124:127], v[64:67], v[32:35]
  v_mfma_f32_16x16x32_bf16 v[28:31], v[124:127], v[60:63], v[28:31]
  v_mfma_f32_16x16x32_bf16 v[24:27], v[124:127], v[56:59], v[24:27]
  s_add_u32 s43, s41, 13312
  s_add_u32 s44, s41, 31744
  buffer_load_dwordx4 v[120:123], v2, s[8:11], s43 offen sc1
  buffer_load_dwordx4 v[124:127], v2, s[8:11], s44 offen sc1
  s_add_u32 s36, s27, 100
  v_mov_b32 v160, s36
L_lw_13:
  ds_read_b32 v161, v160
  s_waitcnt lgkmcnt(0)
  v_readfirstlane_b32 s36, v161
  s_nop 3
  s_cmp_ge_u32 s36, 4
  s_cbranch_scc1 L_lw_13_ok
  s_sleep 2
  s_branch L_lw_13
L_lw_13_ok:
  ds_read_b128 v[40:43], v5 offset:24576
  ds_read_b128 v[44:47], v5 offset:24832
  ds_read_b128 v[48:51], v5 offset:25088
  ds_read_b128 v[52:55], v5 offset:25344
  ds_read_b128 v[56:59], v5 offset:28672
  ds_read_b128 v[60:63], v5 offset:28928
  ds_read_b128 v[64:67], v5 offset:29184
  ds_read_b128 v[68:71], v5 offset:29440
  s_waitcnt vmcnt(16)
  v_mfma_f32_16x16x32_bf16 v[8:11], v[128:131], v[72:75], v[8:11]
  v_mfma_f32_16x16x32_bf16 v[12:15], v[128:131], v[76:79], v[12:15]
  v_mfma_f32_16x16x32_bf16 v[16:19], v[128:131], v[80:83], v[16:19]
  v_mfma_f32_16x16x32_bf16 v[20:23], v[128:131], v[84:87], v[20:23]
  v_mfma_f32_16x16x32_bf16 v[36:39], v[132:135], v[84:87], v[36:39]
  v_mfma_f32_16x16x32_bf16 v[32:35], v[132:135], v[80:83], v[32:35]
  v_mfma_f32_16x16x32_bf16 v[28:31], v[132:135], v[76:79], v[28:31]
  v_mfma_f32_16x16x32_bf16 v[24:27], v[132:135], v[72:75], v[24:27]
  s_add_u32 s43, s41, 14336
  s_add_u32 s44, s41, 32768
  buffer_load_dwordx4 v[128:131], v2, s[8:11], s43 offen sc1
  buffer_load_dwordx4 v[132:135], v2, s[8:11], s44 offen sc1
  ds_read_b128 v[72:75], v5 offset:32768
  ds_read_b128 v[76:79], v5 offset:33024
  ds_read_b128 v[80:83], v5 offset:33280
  ds_read_b128 v[84:87], v5 offset:33536
  s_waitcnt vmcnt(16) lgkmcnt(8)
  v_mfma_f32_16x16x32_bf16 v[8:11], v[136:139], v[40:43], v[8:11]
  v_mfma_f32_16x16x32_bf16 v[12:15], v[136:139], v[44:47], v[12:15]
  v_mfma_f32_16x16x32_bf16 v[16:19], v[136:139], v[48:51], v[16:19]
  v_mfma_f32_16x16x32_bf16 v[20:23], v[136:139], v[52:55], v[20:23]
  v_mfma_f32_16x16x32_bf16 v[36:39], v[140:143], v[52:55], v[36:39]
  v_mfma_f32_16x16x32_bf16 v[32:35], v[140:143], v[48:51], v[32:35]
  v_mfma_f32_16x16x32_bf16 v[28:31], v[140:143], v[44:47], v[28:31]
  v_mfma_f32_16x16x32_bf16 v[24:27], v[140:143], v[40:43], v[24:27]
  s_add_u32 s43, s41, 15360
  s_add_u32 s44, s41, 33792
  buffer_load_dwordx4 v[136:139], v2, s[8:11], s43 offen sc1
  buffer_load_dwordx4 v[140:143], v2, s[8:11], s44 offen sc1
  ds_read_b128 v[40:43], v5 offset:36864
  ds_read_b128 v[44:47], v5 offset:37120
  ds_read_b128 v[48:51], v5 offset:37376
  ds_read_b128 v[52:55], v5 offset:37632
  s_waitcnt vmcnt(16) lgkmcnt(8)
  v_mfma_f32_16x16x32_bf16 v[8:11], v[144:147], v[56:59], v[8:11]
  v_mfma_f32_16x16x32_bf16 v[12:15], v[144:147], v[60:63], v[12:15]
  v_mfma_f32_16x16x32_bf16 v[16:19], v[144:147], v[64:67], v[16:19]
  v_mfma_f32_16x16x32_bf16 v[20:23], v[144:147], v[68:71], v[20:23]
  v_mfma_f32_16x16x32_bf16 v[36:39], v[148:151], v[68:71], v[36:39]
  v_mfma_f32_16x16x32_bf16 v[32:35], v[148:151], v[64:67], v[32:35]
  v_mfma_f32_16x16x32_bf16 v[28:31], v[148:151], v[60:63], v[28:31]
  v_mfma_f32_16x16x32_bf16 v[24:27], v[148:151], v[56:59], v[24:27]
  s_add_u32 s43, s41, 16384
  s_add_u32 s44, s41, 34816
  buffer_load_dwordx4 v[144:147], v2, s[8:11], s43 offen sc1
  buffer_load_dwordx4 v[148:151], v2, s[8:11], s44 offen sc1
  ds_read_b128 v[56:59], v5 offset:40960
  ds_read_b128 v[60:63], v5 offset:41216
  ds_read_b128 v[64:67], v5 offset:41472
  ds_read_b128 v[68:71], v5 offset:41728
  s_waitcnt vmcnt(16) lgkmcnt(8)
  v_mfma_f32_16x16x32_bf16 v[8:11], v[152:155], v[72:75], v[8:11]
  v_mfma_f32_16x16x32_bf16 v[12:15], v[152:155], v[76:79], v[12:15]
  v_mfma_f32_16x16x32_bf16 v[16:19], v[152:155], v[80:83], v[16:19]
  v_mfma_f32_16x16x32_bf16 v[20:23], v[152:155], v[84:87], v[20:23]
  v_mfma_f32_16x16x32_bf16 v[36:39], v[156:159], v[84:87], v[36:39]
  v_mfma_f32_16x16x32_bf16 v[32:35], v[156:159], v[80:83], v[32:35]
  v_mfma_f32_16x16x32_bf16 v[28:31], v[156:159], v[76:79], v[28:31]
  v_mfma_f32_16x16x32_bf16 v[24:27], v[156:159], v[72:75], v[24:27]
  s_add_u32 s43, s41, 17408
  s_add_u32 s44, s41, 35840
  buffer_load_dwordx4 v[152:155], v2, s[8:11], s43 offen sc1
  buffer_load_dwordx4 v[156:159], v2, s[8:11], s44 offen sc1
  ds_read_b128 v[72:75], v5 offset:45056
  ds_read_b128 v[76:79], v5 offset:45312
  ds_read_b128 v[80:83], v5 offset:45568
  ds_read_b128 v[84:87], v5 offset:45824
  s_waitcnt vmcnt(16) lgkmcnt(8)
  v_mfma_f32_16x16x32_bf16 v[8:11], v[88:91], v[40:43], v[8:11]
  v_mfma_f32_16x16x32_bf16 v[12:15], v[88:91], v[44:47], v[12:15]
  v_mfma_f32_16x16x32_bf16 v[16:19], v[88:91], v[48:51], v[16:19]
  v_mfma_f32_16x16x32_bf16 v[20:23], v[88:91], v[52:55], v[20:23]
  v_mfma_f32_16x16x32_bf16 v[36:39], v[92:95], v[52:55], v[36:39]
  v_mfma_f32_16x16x32_bf16 v[32:35], v[92:95], v[48:51], v[32:35]
  v_mfma_f32_16x16x32_bf16 v[28:31], v[92:95], v[44:47], v[28:31]
  v_mfma_f32_16x16x32_bf16 v[24:27], v[92:95], v[40:43], v[24:27]
  s_waitcnt vmcnt(14) lgkmcnt(4)
  v_mfma_f32_16x16x32_bf16 v[8:11], v[96:99], v[56:59], v[8:11]
  v_mfma_f32_16x16x32_bf16 v[12:15], v[96:99], v[60:63], v[12:15]
  v_mfma_f32_16x16x32_bf16 v[16:19], v[96:99], v[64:67], v[16:19]
  v_mfma_f32_16x16x32_bf16 v[20:23], v[96:99], v[68:71], v[20:23]
  v_mfma_f32_16x16x32_bf16 v[36:39], v[100:103], v[68:71], v[36:39]
  v_mfma_f32_16x16x32_bf16 v[32:35], v[100:103], v[64:67], v[32:35]
  v_mfma_f32_16x16x32_bf16 v[28:31], v[100:103], v[60:63], v[28:31]
  v_mfma_f32_16x16x32_bf16 v[24:27], v[100:103], v[56:59], v[24:27]
  s_add_u32 s36, s27, 104
  v_mov_b32 v160, s36
L_lw_14:
  ds_read_b32 v161, v160
  s_waitcnt lgkmcnt(0)
  v_readfirstlane_b32 s36, v161
  s_nop 3
  s_cmp_ge_u32 s36, 4
  s_cbranch_scc1 L_lw_14_ok
  s_sleep 2
  s_branch L_lw_14
L_lw_14_ok:
  ds_read_b128 v[40:43], v6 offset:0
  ds_read_b128 v[44:47], v6 offset:256
  ds_read_b128 v[48:51], v6 offset:512
  ds_read_b128 v[52:55], v6 offset:768
  ds_read_b128 v[56:59], v6 offset:4096
  ds_read_b128 v[60:63], v6 offset:4352
  ds_read_b128 v[64:67], v6 offset:4608
  ds_read_b128 v[68:71], v6 offset:4864
  s_waitcnt vmcnt(12)
  v_mfma_f32_16x16x32_bf16 v[8:11], v[104:107], v[72:75], v[8:11]
  v_mfma_f32_16x16x32_bf16 v[12:15], v[104:107], v[76:79], v[12:15]
  v_mfma_f32_16x16x32_bf16 v[16:19], v[104:107], v[80:83], v[16:19]
  v_mfma_f32_16x16x32_bf16 v[20:23], v[104:107], v[84:87], v[20:23]
  v_mfma_f32_16x16x32_bf16 v[36:39], v[108:111], v[84:87], v[36:39]
  v_mfma_f32_16x16x32_bf16 v[32:35], v[108:111], v[80:83], v[32:35]
  v_mfma_f32_16x16x32_bf16 v[28:31], v[108:111], v[76:79], v[28:31]
  v_mfma_f32_16x16x32_bf16 v[24:27], v[108:111], v[72:75], v[24:27]
  ds_read_b128 v[72:75], v6 offset:8192
  ds_read_b128 v[76:79], v6 offset:8448
  ds_read_b128 v[80:83], v6 offset:8704
  ds_read_b128 v[84:87], v6 offset:8960
  s_waitcnt vmcnt(10) lgkmcnt(8)
  v_mfma_f32_16x16x32_bf16 v[8:11], v[112:115], v[40:43], v[8:11]
  v_mfma_f32_16x16x32_bf16 v[12:15], v[112:115], v[44:47], v[12:15]
  v_mfma_f32_16x16x32_bf16 v[16:19], v[112:115], v[48:51], v[16:19]
  v_mfma_f32_16x16x32_bf16 v[20:23], v[112:115], v[52:55], v[20:23]
  v_mfma_f32_16x16x32_bf16 v[36:39], v[116:119], v[52:55], v[36:39]
  v_mfma_f32_16x16x32_bf16 v[32:35], v[116:119], v[48:51], v[32:35]
  v_mfma_f32_16x16x32_bf16 v[28:31], v[116:119], v[44:47], v[28:31]
  v_mfma_f32_16x16x32_bf16 v[24:27], v[116:119], v[40:43], v[24:27]
  ds_read_b128 v[40:43], v6 offset:12288
  ds_read_b128 v[44:47], v6 offset:12544
  ds_read_b128 v[48:51], v6 offset:12800
  ds_read_b128 v[52:55], v6 offset:13056
  s_waitcnt vmcnt(8) lgkmcnt(8)
  v_mfma_f32_16x16x32_bf16 v[8:11], v[120:123], v[56:59], v[8:11]
  v_mfma_f32_16x16x32_bf16 v[12:15], v[120:123], v[60:63], v[12:15]
  v_mfma_f32_16x16x32_bf16 v[16:19], v[120:123], v[64:67], v[16:19]
  v_mfma_f32_16x16x32_bf16 v[20:23], v[120:123], v[68:71], v[20:23]
  v_mfma_f32_16x16x32_bf16 v[36:39], v[124:127], v[68:71], v[36:39]
  v_mfma_f32_16x16x32_bf16 v[32:35], v[124:127], v[64:67], v[32:35]
  v_mfma_f32_16x16x32_bf16 v[28:31], v[124:127], v[60:63], v[28:31]
  v_mfma_f32_16x16x32_bf16 v[24:27], v[124:127], v[56:59], v[24:27]
  buffer_load_dwordx4 v[124:127], v2, s[8:11], s58 offen offset:0 sc1
  ds_read_b128 v[56:59], v6 offset:16384
  ds_read_b128 v[60:63], v6 offset:16640
  ds_read_b128 v[64:67], v6 offset:16896
  ds_read_b128 v[68:71], v6 offset:17152
  s_waitcnt vmcnt(7) lgkmcnt(8)
  v_mfma_f32_16x16x32_bf16 v[8:11], v[128:131], v[72:75], v[8:11]
  v_mfma_f32_16x16x32_bf16 v[12:15], v[128:131], v[76:79], v[12:15]
  v_mfma_f32_16x16x32_bf16 v[16:19], v[128:131], v[80:83], v[16:19]
  v_mfma_f32_16x16x32_bf16 v[20:23], v[128:131], v[84:87], v[20:23]
  v_mfma_f32_16x16x32_bf16 v[36:39], v[132:135], v[84:87], v[36:39]
  v_mfma_f32_16x16x32_bf16 v[32:35], v[132:135], v[80:83], v[32:35]
  v_mfma_f32_16x16x32_bf16 v[28:31], v[132:135], v[76:79], v[28:31]
  v_mfma_f32_16x16x32_bf16 v[24:27], v[132:135], v[72:75], v[24:27]
  buffer_load_dwordx4 v[128:131], v2, s[8:11], s58 offen offset:1024 sc1
  buffer_load_dwordx4 v[132:135], v2, s[8:11], s58 offen offset:2048 sc1
  ds_read_b128 v[72:75], v6 offset:20480
  ds_read_b128 v[76:79], v6 offset:20736
  ds_read_b128 v[80:83], v6 offset:20992
  ds_read_b128 v[84:87], v6 offset:21248
  s_waitcnt vmcnt(7) lgkmcnt(8)
  v_mfma_f32_16x16x32_bf16 v[8:11], v[136:139], v[40:43], v[8:11]
  v_mfma_f32_16x16x32_bf16 v[12:15], v[136:139], v[44:47], v[12:15]
  v_mfma_f32_16x16x32_bf16 v[16:19], v[136:139], v[48:51], v[16:19]
  v_mfma_f32_16x16x32_bf16 v[20:23], v[136:139], v[52:55], v[20:23]
  v_mfma_f32_16x16x32_bf16 v[36:39], v[140:143], v[52:55], v[36:39]
  v_mfma_f32_16x16x32_bf16 v[32:35], v[140:143], v[48:51], v[32:35]
  v_mfma_f32_16x16x32_bf16 v[28:31], v[140:143], v[44:47], v[28:31]
  v_mfma_f32_16x16x32_bf16 v[24:27], v[140:143], v[40:43], v[24:27]
  buffer_load_dwordx4 v[136:139], v2, s[8:11], s58 offen offset:3072 sc1
  s_add_u32 s58, s58, 4096
  buffer_load_dwordx4 v[140:143], v2, s[8:11], s58 offen offset:0 sc1
  s_waitcnt vmcnt(7) lgkmcnt(4)
  v_mfma_f32_16x16x32_bf16 v[8:11], v[144:147], v[56:59], v[8:11]
  v_mfma_f32_16x16x32_bf16 v[12:15], v[144:147], v[60:63], v[12:15]
  v_mfma_f32_16x16x32_bf16 v[16:19], v[144:147], v[64:67], v[16:19]
  v_mfma_f32_16x16x32_bf16 v[20:23], v[144:147], v[68:71], v[20:23]
  v_mfma_f32_16x16x32_bf16 v[36:39], v[148:151], v[68:71], v[36:39]
  v_mfma_f32_16x16x32_bf16 v[32:35], v[148:151], v[64:67], v[32:35]
  v_mfma_f32_16x16x32_bf16 v[28:31], v[148:151], v[60:63], v[28:31]
  v_mfma_f32_16x16x32_bf16 v[24:27], v[148:151], v[56:59], v[24:27]
  buffer_load_dwordx4 v[144:147], v2, s[8:11], s58 offen offset:1024 sc1
  buffer_load_dwordx4 v[148:151], v2, s[8:11], s58 offen offset:2048 sc1
  s_waitcnt vmcnt(7) lgkmcnt(0)
  v_mfma_f32_16x16x32_bf16 v[8:11], v[152:155], v[72:75], v[8:11]
  v_mfma_f32_16x16x32_bf16 v[12:15], v[152:155], v[76:79], v[12:15]
  v_mfma_f32_16x16x32_bf16 v[16:19], v[152:155], v[80:83], v[16:19]
  v_mfma_f32_16x16x32_bf16 v[20:23], v[152:155], v[84:87], v[20:23]
  v_mfma_f32_16x16x32_bf16 v[36:39], v[156:159], v[84:87], v[36:39]
  v_mfma_f32_16x16x32_bf16 v[32:35], v[156:159], v[80:83], v[32:35]
  v_mfma_f32_16x16x32_bf16 v[28:31], v[156:159], v[76:79], v[28:31]
  v_mfma_f32_16x16x32_bf16 v[24:27], v[156:159], v[72:75], v[24:27]
  buffer_load_dwordx4 v[152:155], v2, s[8:11], s58 offen offset:3072 sc1
  s_add_u32 s58, s58, 4096
  buffer_load_dwordx4 v[156:159], v2, s[8:11], s58 offen offset:0 sc1
  s_add_u32 s36, s27, 0
  v_mov_b32 v40, s36
L_lw_15:
  ds_read_b32 v41, v40
  s_waitcnt lgkmcnt(0)
  v_readfirstlane_b32 s36, v41
  s_nop 3
  s_cmp_ge_u32 s36, 3
  s_cbranch_scc1 L_lw_15_ok
  s_sleep 2
  s_branch L_lw_15
L_lw_15_ok:
  v_lshlrev_b32 v45, 3, v4
  v_add_u32 v45, 151040, v45
  ds_read_b64 v[46:47], v45 offset:128
  ds_read_b64 v[48:49], v45 offset:256
  ds_read_b64 v[50:51], v45 offset:384
  ds_read_b64 v[52:53], v45 offset:512
  v_lshlrev_b32 v42, 2, v3
  s_add_u32 s36, s40, 0
  s_lshl_b32 s36, s36, 4
  v_add_u32 v42, s36, v42
  s_mov_b32 s36, 160768
  v_lshl_add_u32 v45, v42, 2, s36
  ds_read_b128 v[160:163], v45
  s_mov_b32 s36, 57
  v_mul_u32_u24 v43, s36, v42
  v_lshrrev_b32 v43, 10, v43
  s_movk_i32 s36, 3932
  v_mul_u32_u24 v40, s36, v43
  v_lshl_add_u32 v40, v42, 1, v40
  v_mul_u32_u24 v44, 48, v4
  s_mov_b32 s36, 92160
  v_add3_u32 v40, v40, v44, s36
  v_add_u32 v42, 2, v42
  s_mov_b32 s36, 57
  v_mul_u32_u24 v43, s36, v42
  v_lshrrev_b32 v43, 10, v43
  s_movk_i32 s36, 3932
  v_mul_u32_u24 v41, s36, v43
  v_lshl_add_u32 v41, v42, 1, v41
  v_mul_u32_u24 v44, 48, v4
  s_mov_b32 s36, 92160
  v_add3_u32 v41, v41, v44, s36
  s_waitcnt lgkmcnt(0)
  v_mul_f32 v8, v8, v46
  v_fmac_f32 v8, v47, v160
  v_mul_f32 v9, v9, v46
  v_fmac_f32 v9, v47, v161
  v_mul_f32 v10, v10, v46
  v_fmac_f32 v10, v47, v162
  v_mul_f32 v11, v11, v46
  v_fmac_f32 v11, v47, v163
  v_cvt_pk_bf16_f32 v8, v8, v9
  v_cvt_pk_bf16_f32 v9, v10, v11
  ds_write_b32 v40, v8 offset:768
  ds_write_b32 v41, v9 offset:768
  v_mul_f32 v12, v12, v48
  v_fmac_f32 v12, v49, v160
  v_mul_f32 v13, v13, v48
  v_fmac_f32 v13, v49, v161
  v_mul_f32 v14, v14, v48
  v_fmac_f32 v14, v49, v162
  v_mul_f32 v15, v15, v48
  v_fmac_f32 v15, v49, v163
  v_cvt_pk_bf16_f32 v12, v12, v13
  v_cvt_pk_bf16_f32 v13, v14, v15
  ds_write_b32 v40, v12 offset:1536
  ds_write_b32 v41, v13 offset:1536
  v_mul_f32 v16, v16, v50
  v_fmac_f32 v16, v51, v160
  v_mul_f32 v17, v17, v50
  v_fmac_f32 v17, v51, v161
  v_mul_f32 v18, v18, v50
  v_fmac_f32 v18, v51, v162
  v_mul_f32 v19, v19, v50
  v_fmac_f32 v19, v51, v163
  v_cvt_pk_bf16_f32 v16, v16, v17
  v_cvt_pk_bf16_f32 v17, v18, v19
  ds_write_b32 v40, v16 offset:2304
  ds_write_b32 v41, v17 offset:2304
  v_mul_f32 v20, v20, v52
  v_fmac_f32 v20, v53, v160
  v_mul_f32 v21, v21, v52
  v_fmac_f32 v21, v53, v161
  v_mul_f32 v22, v22, v52
  v_fmac_f32 v22, v53, v162
  v_mul_f32 v23, v23, v52
  v_fmac_f32 v23, v53, v163
  v_cvt_pk_bf16_f32 v20, v20, v21
  v_cvt_pk_bf16_f32 v21, v22, v23
  ds_write_b32 v40, v20 offset:3072
  ds_write_b32 v41, v21 offset:3072
  v_lshlrev_b32 v42, 2, v3
  s_add_u32 s36, s40, 1
  s_lshl_b32 s36, s36, 4
  v_add_u32 v42, s36, v42
  s_mov_b32 s36, 160768
  v_lshl_add_u32 v45, v42, 2, s36
  ds_read_b128 v[164:167], v45
  s_mov_b32 s36, 57
  v_mul_u32_u24 v43, s36, v42
  v_lshrrev_b32 v43, 10, v43
  s_movk_i32 s36, 3932
  v_mul_u32_u24 v40, s36, v43
  v_lshl_add_u32 v40, v42, 1, v40
  v_mul_u32_u24 v44, 48, v4
  s_mov_b32 s36, 92160
  v_add3_u32 v40, v40, v44, s36
  v_add_u32 v42, 2, v42
  s_mov_b32 s36, 57
  v_mul_u32_u24 v43, s36, v42
  v_lshrrev_b32 v43, 10, v43
  s_movk_i32 s36, 3932
  v_mul_u32_u24 v41, s36, v43
  v_lshl_add_u32 v41, v42, 1, v41
  v_mul_u32_u24 v44, 48, v4
  s_mov_b32 s36, 92160
  v_add3_u32 v41, v41, v44, s36
  s_waitcnt lgkmcnt(0)
  v_mul_f32 v24, v24, v46
  v_fmac_f32 v24, v47, v164
  v_mul_f32 v25, v25, v46
  v_fmac_f32 v25, v47, v165
  v_mul_f32 v26, v26, v46
  v_fmac_f32 v26, v47, v166
  v_mul_f32 v27, v27, v46
  v_fmac_f32 v27, v47, v167
  v_cvt_pk_bf16_f32 v24, v24, v25
  v_cvt_pk_bf16_f32 v25, v26, v27
  ds_write_b32 v40, v24 offset:768
  ds_write_b32 v41, v25 offset:768
  v_mul_f32 v28, v28, v48
  v_fmac_f32 v28, v49, v164
  v_mul_f32 v29, v29, v48
  v_fmac_f32 v29, v49, v165
  v_mul_f32 v30, v30, v48
  v_fmac_f32 v30, v49, v166
  v_mul_f32 v31, v31, v48
  v_fmac_f32 v31, v49, v167
  v_cvt_pk_bf16_f32 v28, v28, v29
  v_cvt_pk_bf16_f32 v29, v30, v31
  ds_write_b32 v40, v28 offset:1536
  ds_write_b32 v41, v29 offset:1536
  v_mul_f32 v32, v32, v50
  v_fmac_f32 v32, v51, v164
  v_mul_f32 v33, v33, v50
  v_fmac_f32 v33, v51, v165
  v_mul_f32 v34, v34, v50
  v_fmac_f32 v34, v51, v166
  v_mul_f32 v35, v35, v50
  v_fmac_f32 v35, v51, v167
  v_cvt_pk_bf16_f32 v32, v32, v33
  v_cvt_pk_bf16_f32 v33, v34, v35
  ds_write_b32 v40, v32 offset:2304
  ds_write_b32 v41, v33 offset:2304
  v_mul_f32 v36, v36, v52
  v_fmac_f32 v36, v53, v164
  v_mul_f32 v37, v37, v52
  v_fmac_f32 v37, v53, v165
  v_mul_f32 v38, v38, v52
  v_fmac_f32 v38, v53, v166
  v_mul_f32 v39, v39, v52
  v_fmac_f32 v39, v53, v167
  v_cvt_pk_bf16_f32 v36, v36, v37
  v_cvt_pk_bf16_f32 v37, v38, v39
  ds_write_b32 v40, v36 offset:3072
  ds_write_b32 v41, v37 offset:3072
  s_branch L_A_att
L_A_single:
  s_cmp_eq_u32 s40, 13
  s_cselect_b32 s36, 0xffffff7f, -1
  v_and_b32 v0, s36, v2
  s_add_u32 s43, s41, 0
  buffer_load_dwordx4 v[88:91], v0, s[8:11], s43 offen sc1
  s_add_u32 s43, s41, 1024
  buffer_load_dwordx4 v[92:95], v0, s[8:11], s43 offen sc1
  s_add_u32 s43, s41, 2048
  buffer_load_dwordx4 v[96:99], v0, s[8:11], s43 offen sc1
  s_add_u32 s43, s41, 3072
  buffer_load_dwordx4 v[100:103], v0, s[8:11], s43 offen sc1
  s_add_u32 s43, s41, 4096
  buffer_load_dwordx4 v[104:107], v0, s[8:11], s43 offen sc1
  s_add_u32 s43, s41, 5120
  buffer_load_dwordx4 v[108:111], v0, s[8:11], s43 offen sc1
  s_add_u32 s36, s27, 96
  v_mov_b32 v160, s36
L_lw_16:
  ds_read_b32 v161, v160
  s_waitcnt lgkmcnt(0)
  v_readfirstlane_b32 s36, v161
  s_nop 3
  s_cmp_ge_u32 s36, 4
  s_cbranch_scc1 L_lw_16_ok
  s_sleep 2
  s_branch L_lw_16
L_lw_16_ok:
  ds_read_b128 v[28:31], v7 offset:0
  ds_read_b128 v[32:35], v5 offset:0
  ds_read_b128 v[36:39], v5 offset:256
  ds_read_b128 v[40:43], v5 offset:512
  ds_read_b128 v[44:47], v5 offset:768
  ds_read_b128 v[48:51], v7 offset:1024
  ds_read_b128 v[52:55], v5 offset:4096
  ds_read_b128 v[56:59], v5 offset:4352
  ds_read_b128 v[60:63], v5 offset:4608
  ds_read_b128 v[64:67], v5 offset:4864
  ds_read_b128 v[68:71], v7 offset:2048
  ds_read_b128 v[72:75], v5 offset:8192
  ds_read_b128 v[76:79], v5 offset:8448
  ds_read_b128 v[80:83], v5 offset:8704
  ds_read_b128 v[84:87], v5 offset:8960
  s_waitcnt vmcnt(5) lgkmcnt(10)
  v_mfma_f32_16x16x32_bf16 v[8:11], v[88:91], v[28:31], 0
  v_mfma_f32_16x16x32_bf16 v[12:15], v[88:91], v[32:35], 0
  v_mfma_f32_16x16x32_bf16 v[16:19], v[88:91], v[36:39], 0
  v_mfma_f32_16x16x32_bf16 v[20:23], v[88:91], v[40:43], 0
  v_mfma_f32_16x16x32_bf16 v[24:27], v[88:91], v[44:47], 0
  s_add_u32 s43, s41, 6144
  buffer_load_dwordx4 v[112:115], v0, s[8:11], s43 offen sc1
  ds_read_b128 v[28:31], v7 offset:3072
  ds_read_b128 v[32:35], v5 offset:12288
  ds_read_b128 v[36:39], v5 offset:12544
  ds_read_b128 v[40:43], v5 offset:12800
  ds_read_b128 v[44:47], v5 offset:13056
  s_waitcnt vmcnt(5) lgkmcnt(10)
  v_mfma_f32_16x16x32_bf16 v[8:11], v[92:95], v[48:51], v[8:11]
  v_mfma_f32_16x16x32_bf16 v[12:15], v[92:95], v[52:55], v[12:15]
  v_mfma_f32_16x16x32_bf16 v[16:19], v[92:95], v[56:59], v[16:19]
  v_mfma_f32_16x16x32_bf16 v[20:23], v[92:95], v[60:63], v[20:23]
  v_mfma_f32_16x16x32_bf16 v[24:27], v[92:95], v[64:67], v[24:27]
  s_add_u32 s43, s41, 7168
  buffer_load_dwordx4 v[116:119], v0, s[8:11], s43 offen sc1
  ds_read_b128 v[48:51], v7 offset:4096
  ds_read_b128 v[52:55], v5 offset:16384
  ds_read_b128 v[56:59], v5 offset:16640
  ds_read_b128 v[60:63], v5 offset:16896
  ds_read_b128 v[64:67], v5 offset:17152
  s_waitcnt vmcnt(5) lgkmcnt(10)
  v_mfma_f32_16x16x32_bf16 v[8:11], v[96:99], v[68:71], v[8:11]
  v_mfma_f32_16x16x32_bf16 v[12:15], v[96:99], v[72:75], v[12:15]
  v_mfma_f32_16x16x32_bf16 v[16:19], v[96:99], v[76:79], v[16:19]
  v_mfma_f32_16x16x32_bf16 v[20:23], v[96:99], v[80:83], v[20:23]
  v_mfma_f32_16x16x32_bf16 v[24:27], v[96:99], v[84:87], v[24:27]
  s_add_u32 s43, s41, 8192
  buffer_load_dwordx4 v[120:123], v0, s[8:11], s43 offen sc1
  ds_read_b128 v[68:71], v7 offset:5120
  ds_read_b128 v[72:75], v5 offset:20480
  ds_read_b128 v[76:79], v5 offset:20736
  ds_read_b128 v[80:83], v5 offset:20992
  ds_read_b128 v[84:87], v5 offset:21248
  s_waitcnt vmcnt(5) lgkmcnt(10)
  v_mfma_f32_16x16x32_bf16 v[8:11], v[100:103], v[28:31], v[8:11]
  v_mfma_f32_16x16x32_bf16 v[12:15], v[100:103], v[32:35], v[12:15]
  v_mfma_f32_16x16x32_bf16 v[16:19], v[100:103], v[36:39], v[16:19]
  v_mfma_f32_16x16x32_bf16 v[20:23], v[100:103], v[40:43], v[20:23]
  v_mfma_f32_16x16x32_bf16 v[24:27], v[100:103], v[44:47], v[24:27]
  s_add_u32 s43, s41, 9216
  buffer_load_dwordx4 v[124:127], v0, s[8:11], s43 offen sc1
  s_waitcnt vmcnt(5) lgkmcnt(5)
  v_mfma_f32_16x16x32_bf16 v[8:11], v[104:107], v[48:51], v[8:11]
  v_mfma_f32_16x16x32_bf16 v[12:15], v[104:107], v[52:55], v[12:15]
  v_mfma_f32_16x16x32_bf16 v[16:19], v[104:107], v[56:59], v[16:19]
  v_mfma_f32_16x16x32_bf16 v[20:23], v[104:107], v[60:63], v[20:23]
  v_mfma_f32_16x16x32_bf16 v[24:27], v[104:107], v[64:67], v[24:27]
  s_add_u32 s43, s41, 10240
  buffer_load_dwordx4 v[128:131], v0, s[8:11], s43 offen sc1
  s_add_u32 s36, s27, 100
  v_mov_b32 v160, s36
L_lw_17:
  ds_read_b32 v161, v160
  s_waitcnt lgkmcnt(0)
  v_readfirstlane_b32 s36, v161
  s_nop 3
  s_cmp_ge_u32 s36, 4
  s_cbranch_scc1 L_lw_17_ok
  s_sleep 2
  s_branch L_lw_17
L_lw_17_ok:
  ds_read_b128 v[28:31], v7 offset:6144
  ds_read_b128 v[32:35], v5 offset:24576
  ds_read_b128 v[36:39], v5 offset:24832
  ds_read_b128 v[40:43], v5 offset:25088
  ds_read_b128 v[44:47], v5 offset:25344
  ds_read_b128 v[48:51], v7 offset:7168
  ds_read_b128 v[52:55], v5 offset:28672
  ds_read_b128 v[56:59], v5 offset:28928
  ds_read_b128 v[60:63], v5 offset:29184
  ds_read_b128 v[64:67], v5 offset:29440
  s_waitcnt vmcnt(5)
  v_mfma_f32_16x16x32_bf16 v[8:11], v[108:111], v[68:71], v[8:11]
  v_mfma_f32_16x16x32_bf16 v[12:15], v[108:111], v[72:75], v[12:15]
  v_mfma_f32_16x16x32_bf16 v[16:19], v[108:111], v[76:79], v[16:19]
  v_mfma_f32_16x16x32_bf16 v[20:23], v[108:111], v[80:83], v[20:23]
  v_mfma_f32_16x16x32_bf16 v[24:27], v[108:111], v[84:87], v[24:27]
  s_add_u32 s43, s41, 11264
  buffer_load_dwordx4 v[132:135], v0, s[8:11], s43 offen sc1
  ds_read_b128 v[68:71], v7 offset:8192
  ds_read_b128 v[72:75], v5 offset:32768
  ds_read_b128 v[76:79], v5 offset:33024
  ds_read_b128 v[80:83], v5 offset:33280
  ds_read_b128 v[84:87], v5 offset:33536
  s_waitcnt vmcnt(5) lgkmcnt(10)
  v_mfma_f32_16x16x32_bf16 v[8:11], v[112:115], v[28:31], v[8:11]
  v_mfma_f32_16x16x32_bf16 v[12:15], v[112:115], v[32:35], v[12:15]
  v_mfma_f32_16x16x32_bf16 v[16:19], v[112:115], v[36:39], v[16:19]
  v_mfma_f32_16x16x32_bf16 v[20:23], v[112:115], v[40:43], v[20:23]
  v_mfma_f32_16x16x32_bf16 v[24:27], v[112:115], v[44:47], v[24:27]
  s_add_u32 s43, s41, 12288
  buffer_load_dwordx4 v[136:139], v0, s[8:11], s43 offen sc1
  ds_read_b128 v[28:31], v7 offset:9216
  ds_read_b128 v[32:35], v5 offset:36864
  ds_read_b128 v[36:39], v5 offset:37120
  ds_read_b128 v[40:43], v5 offset:37376
  ds_read_b128 v[44:47], v5 offset:37632
  s_waitcnt vmcnt(5) lgkmcnt(10)
  v_mfma_f32_16x16x32_bf16 v[8:11], v[116:119], v[48:51], v[8:11]
  v_mfma_f32_16x16x32_bf16 v[12:15], v[116:119], v[52:55], v[12:15]
  v_mfma_f32_16x16x32_bf16 v[16:19], v[116:119], v[56:59], v[16:19]
  v_mfma_f32_16x16x32_bf16 v[20:23], v[116:119], v[60:63], v[20:23]
  v_mfma_f32_16x16x32_bf16 v[24:27], v[116:119], v[64:67], v[24:27]
  s_add_u32 s43, s41, 13312
  buffer_load_dwordx4 v[140:143], v0, s[8:11], s43 offen sc1
  ds_read_b128 v[48:51], v7 offset:10240
  ds_read_b128 v[52:55], v5 offset:40960
  ds_read_b128 v[56:59], v5 offset:41216
  ds_read_b128 v[60:63], v5 offset:41472
  ds_read_b128 v[64:67], v5 offset:41728
  s_waitcnt vmcnt(5) lgkmcnt(10)
  v_mfma_f32_16x16x32_bf16 v[8:11], v[120:123], v[68:71], v[8:11]
  v_mfma_f32_16x16x32_bf16 v[12:15], v[120:123], v[72:75], v[12:15]
  v_mfma_f32_16x16x32_bf16 v[16:19], v[120:123], v[76:79], v[16:19]
  v_mfma_f32_16x16x32_bf16 v[20:23], v[120:123], v[80:83], v[20:23]
  v_mfma_f32_16x16x32_bf16 v[24:27], v[120:123], v[84:87], v[24:27]
  s_add_u32 s43, s41, 14336
  buffer_load_dwordx4 v[144:147], v0, s[8:11], s43 offen sc1
  ds_read_b128 v[68:71], v7 offset:11264
  ds_read_b128 v[72:75], v5 offset:45056
  ds_read_b128 v[76:79], v5 offset:45312
  ds_read_b128 v[80:83], v5 offset:45568
  ds_read_b128 v[84:87], v5 offset:45824
  s_waitcnt vmcnt(5) lgkmcnt(10)
  v_mfma_f32_16x16x32_bf16 v[8:11], v[124:127], v[28:31], v[8:11]
  v_mfma_f32_16x16x32_bf16 v[12:15], v[124:127], v[32:35], v[12:15]
  v_mfma_f32_16x16x32_bf16 v[16:19], v[124:127], v[36:39], v[16:19]
  v_mfma_f32_16x16x32_bf16 v[20:23], v[124:127], v[40:43], v[20:23]
  v_mfma_f32_16x16x32_bf16 v[24:27], v[124:127], v[44:47], v[24:27]
  s_add_u32 s43, s41, 15360
  buffer_load_dwordx4 v[148:151], v0, s[8:11], s43 offen sc1
  buffer_load_dwordx4 v[124:127], v2, s[8:11], s58 offen offset:0 sc1
  s_waitcnt vmcnt(6) lgkmcnt(5)
  v_mfma_f32_16x16x32_bf16 v[8:11], v[128:131], v[48:51], v[8:11]
  v_mfma_f32_16x16x32_bf16 v[12:15], v[128:131], v[52:55], v[12:15]
  v_mfma_f32_16x16x32_bf16 v[16:19], v[128:131], v[56:59], v[16:19]
  v_mfma_f32_16x16x32_bf16 v[20:23], v[128:131], v[60:63], v[20:23]
  v_mfma_f32_16x16x32_bf16 v[24:27], v[128:131], v[64:67], v[24:27]
  s_add_u32 s43, s41, 16384
  buffer_load_dwordx4 v[152:155], v0, s[8:11], s43 offen sc1
  buffer_load_dwordx4 v[128:131], v2, s[8:11], s58 offen offset:1024 sc1
  s_add_u32 s36, s27, 104
  v_mov_b32 v160, s36
L_lw_18:
  ds_read_b32 v161, v160
  s_waitcnt lgkmcnt(0)
  v_readfirstlane_b32 s36, v161
  s_nop 3
  s_cmp_ge_u32 s36, 4
  s_cbranch_scc1 L_lw_18_ok
  s_sleep 2
  s_branch L_lw_18
L_lw_18_ok:
  ds_read_b128 v[28:31], v7 offset:12288
  ds_read_b128 v[32:35], v6 offset:0
  ds_read_b128 v[36:39], v6 offset:256
  ds_read_b128 v[40:43], v6 offset:512
  ds_read_b128 v[44:47], v6 offset:768
  ds_read_b128 v[48:51], v7 offset:13312
  ds_read_b128 v[52:55], v6 offset:4096
  ds_read_b128 v[56:59], v6 offset:4352
  ds_read_b128 v[60:63], v6 offset:4608
  ds_read_b128 v[64:67], v6 offset:4864
  s_waitcnt vmcnt(7)
  v_mfma_f32_16x16x32_bf16 v[8:11], v[132:135], v[68:71], v[8:11]
  v_mfma_f32_16x16x32_bf16 v[12:15], v[132:135], v[72:75], v[12:15]
  v_mfma_f32_16x16x32_bf16 v[16:19], v[132:135], v[76:79], v[16:19]
  v_mfma_f32_16x16x32_bf16 v[20:23], v[132:135], v[80:83], v[20:23]
  v_mfma_f32_16x16x32_bf16 v[24:27], v[132:135], v[84:87], v[24:27]
  s_add_u32 s43, s41, 17408
  buffer_load_dwordx4 v[156:159], v0, s[8:11], s43 offen sc1
  buffer_load_dwordx4 v[132:135], v2, s[8:11], s58 offen offset:2048 sc1
  ds_read_b128 v[68:71], v7 offset:14336
  ds_read_b128 v[72:75], v6 offset:8192
  ds_read_b128 v[76:79], v6 offset:8448
  ds_read_b128 v[80:83], v6 offset:8704
  ds_read_b128 v[84:87], v6 offset:8960
  s_waitcnt vmcnt(8) lgkmcnt(10)
  v_mfma_f32_16x16x32_bf16 v[8:11], v[136:139], v[28:31], v[8:11]
  v_mfma_f32_16x16x32_bf16 v[12:15], v[136:139], v[32:35], v[12:15]
  v_mfma_f32_16x16x32_bf16 v[16:19], v[136:139], v[36:39], v[16:19]
  v_mfma_f32_16x16x32_bf16 v[20:23], v[136:139], v[40:43], v[20:23]
  v_mfma_f32_16x16x32_bf16 v[24:27], v[136:139], v[44:47], v[24:27]
  buffer_load_dwordx4 v[136:139], v2, s[8:11], s58 offen offset:3072 sc1
  ds_read_b128 v[28:31], v7 offset:15360
  ds_read_b128 v[32:35], v6 offset:12288
  ds_read_b128 v[36:39], v6 offset:12544
  ds_read_b128 v[40:43], v6 offset:12800
  ds_read_b128 v[44:47], v6 offset:13056
  s_waitcnt vmcnt(8) lgkmcnt(10)
  v_mfma_f32_16x16x32_bf16 v[8:11], v[140:143], v[48:51], v[8:11]
  v_mfma_f32_16x16x32_bf16 v[12:15], v[140:143], v[52:55], v[12:15]
  v_mfma_f32_16x16x32_bf16 v[16:19], v[140:143], v[56:59], v[16:19]
  v_mfma_f32_16x16x32_bf16 v[20:23], v[140:143], v[60:63], v[20:23]
  v_mfma_f32_16x16x32_bf16 v[24:27], v[140:143], v[64:67], v[24:27]
  s_add_u32 s58, s58, 4096
  buffer_load_dwordx4 v[140:143], v2, s[8:11], s58 offen offset:0 sc1
  ds_read_b128 v[48:51], v7 offset:16384
  ds_read_b128 v[52:55], v6 offset:16384
  ds_read_b128 v[56:59], v6 offset:16640
  ds_read_b128 v[60:63], v6 offset:16896
  ds_read_b128 v[64:67], v6 offset:17152
  s_waitcnt vmcnt(8) lgkmcnt(10)
  v_mfma_f32_16x16x32_bf16 v[8:11], v[144:147], v[68:71], v[8:11]
  v_mfma_f32_16x16x32_bf16 v[12:15], v[144:147], v[72:75], v[12:15]
  v_mfma_f32_16x16x32_bf16 v[16:19], v[144:147], v[76:79], v[16:19]
  v_mfma_f32_16x16x32_bf16 v[20:23], v[144:147], v[80:83], v[20:23]
  v_mfma_f32_16x16x32_bf16 v[24:27], v[144:147], v[84:87], v[24:27]
  buffer_load_dwordx4 v[144:147], v2, s[8:11], s58 offen offset:1024 sc1
  ds_read_b128 v[68:71], v7 offset:17408
  ds_read_b128 v[72:75], v6 offset:20480
  ds_read_b128 v[76:79], v6 offset:20736
  ds_read_b128 v[80:83], v6 offset:20992
  ds_read_b128 v[84:87], v6 offset:21248
  s_waitcnt vmcnt(8) lgkmcnt(10)
  v_mfma_f32_16x16x32_bf16 v[8:11], v[148:151], v[28:31], v[8:11]
  v_mfma_f32_16x16x32_bf16 v[12:15], v[148:151], v[32:35], v[12:15]
  v_mfma_f32_16x16x32_bf16 v[16:19], v[148:151], v[36:39], v[16:19]
  v_mfma_f32_16x16x32_bf16 v[20:23], v[148:151], v[40:43], v[20:23]
  v_mfma_f32_16x16x32_bf16 v[24:27], v[148:151], v[44:47], v[24:27]
  buffer_load_dwordx4 v[148:151], v2, s[8:11], s58 offen offset:2048 sc1
  s_waitcnt vmcnt(7) lgkmcnt(5)
  v_mfma_f32_16x16x32_bf16 v[8:11], v[152:155], v[48:51], v[8:11]
  v_mfma_f32_16x16x32_bf16 v[12:15], v[152:155], v[52:55], v[12:15]
  v_mfma_f32_16x16x32_bf16 v[16:19], v[152:155], v[56:59], v[16:19]
  v_mfma_f32_16x16x32_bf16 v[20:23], v[152:155], v[60:63], v[20:23]
  v_mfma_f32_16x16x32_bf16 v[24:27], v[152:155], v[64:67], v[24:27]
  buffer_load_dwordx4 v[152:155], v2, s[8:11], s58 offen offset:3072 sc1
  s_waitcnt vmcnt(6) lgkmcnt(0)
  v_mfma_f32_16x16x32_bf16 v[8:11], v[156:159], v[68:71], v[8:11]
  v_mfma_f32_16x16x32_bf16 v[12:15], v[156:159], v[72:75], v[12:15]
  v_mfma_f32_16x16x32_bf16 v[16:19], v[156:159], v[76:79], v[16:19]
  v_mfma_f32_16x16x32_bf16 v[20:23], v[156:159], v[80:83], v[20:23]
  v_mfma_f32_16x16x32_bf16 v[24:27], v[156:159], v[84:87], v[24:27]
  s_add_u32 s58, s58, 4096
  buffer_load_dwordx4 v[156:159], v2, s[8:11], s58 offen offset:0 sc1
  s_add_u32 s36, s27, 0
  v_mov_b32 v28, s36
L_lw_19:
  ds_read_b32 v29, v28
  s_waitcnt lgkmcnt(0)
  v_readfirstlane_b32 s36, v29
  s_nop 3
  s_cmp_ge_u32 s36, 3
  s_cbranch_scc1 L_lw_19_ok
  s_sleep 2
  s_branch L_lw_19
L_lw_19_ok:
  v_lshlrev_b32 v33, 3, v4
  v_add_u32 v33, 151040, v33
  ds_read_b64 v[34:35], v33 offset:0
  ds_read_b64 v[36:37], v33 offset:128
  ds_read_b64 v[38:39], v33 offset:256
  ds_read_b64 v[40:41], v33 offset:384
  ds_read_b64 v[42:43], v33 offset:512
  s_cmp_ge_u32 s40, 9
  s_cbranch_scc1 L_A_vp
  v_lshlrev_b32 v30, 2, v3
  s_add_u32 s36, s40, 0
  s_lshl_b32 s36, s36, 4
  v_add_u32 v30, s36, v30
  s_mov_b32 s36, 160768
  v_lshl_add_u32 v33, v30, 2, s36
  ds_read_b128 v[160:163], v33
  s_mov_b32 s36, 57
  v_mul_u32_u24 v31, s36, v30
  v_lshrrev_b32 v31, 10, v31
  s_movk_i32 s36, 3932
  v_mul_u32_u24 v28, s36, v31
  v_lshl_add_u32 v28, v30, 1, v28
  v_mul_u32_u24 v32, 48, v4
  s_mov_b32 s36, 92160
  v_add3_u32 v28, v28, v32, s36
  v_add_u32 v30, 2, v30
  s_mov_b32 s36, 57
  v_mul_u32_u24 v31, s36, v30
  v_lshrrev_b32 v31, 10, v31
  s_movk_i32 s36, 3932
  v_mul_u32_u24 v29, s36, v31
  v_lshl_add_u32 v29, v30, 1, v29
  v_mul_u32_u24 v32, 48, v4
  s_mov_b32 s36, 92160
  v_add3_u32 v29, v29, v32, s36
  s_waitcnt lgkmcnt(0)
  v_mul_f32 v8, v8, v34
  v_fmac_f32 v8, v35, v160
  v_mul_f32 v9, v9, v34
  v_fmac_f32 v9, v35, v161
  v_mul_f32 v10, v10, v34
  v_fmac_f32 v10, v35, v162
  v_mul_f32 v11, v11, v34
  v_fmac_f32 v11, v35, v163
  v_cvt_pk_bf16_f32 v8, v8, v9
  v_cvt_pk_bf16_f32 v9, v10, v11
  ds_write_b32 v28, v8 offset:0
  ds_write_b32 v29, v9 offset:0
  v_mul_f32 v12, v12, v36
  v_fmac_f32 v12, v37, v160
  v_mul_f32 v13, v13, v36
  v_fmac_f32 v13, v37, v161
  v_mul_f32 v14, v14, v36
  v_fmac_f32 v14, v37, v162
  v_mul_f32 v15, v15, v36
  v_fmac_f32 v15, v37, v163
  v_cvt_pk_bf16_f32 v12, v12, v13
  v_cvt_pk_bf16_f32 v13, v14, v15
  ds_write_b32 v28, v12 offset:768
  ds_write_b32 v29, v13 offset:768
  v_mul_f32 v16, v16, v38
  v_fmac_f32 v16, v39, v160
  v_mul_f32 v17, v17, v38
  v_fmac_f32 v17, v39, v161
  v_mul_f32 v18, v18, v38
  v_fmac_f32 v18, v39, v162
  v_mul_f32 v19, v19, v38
  v_fmac_f32 v19, v39, v163
  v_cvt_pk_bf16_f32 v16, v16, v17
  v_cvt_pk_bf16_f32 v17, v18, v19
  ds_write_b32 v28, v16 offset:1536
  ds_write_b32 v29, v17 offset:1536
  v_mul_f32 v20, v20, v40
  v_fmac_f32 v20, v41, v160
  v_mul_f32 v21, v21, v40
  v_fmac_f32 v21, v41, v161
  v_mul_f32 v22, v22, v40
  v_fmac_f32 v22, v41, v162
  v_mul_f32 v23, v23, v40
  v_fmac_f32 v23, v41, v163
  v_cvt_pk_bf16_f32 v20, v20, v21
  v_cvt_pk_bf16_f32 v21, v22, v23
  ds_write_b32 v28, v20 offset:2304
  ds_write_b32 v29, v21 offset:2304
  v_mul_f32 v24, v24, v42
  v_fmac_f32 v24, v43, v160
  v_mul_f32 v25, v25, v42
  v_fmac_f32 v25, v43, v161
  v_mul_f32 v26, v26, v42
  v_fmac_f32 v26, v43, v162
  v_mul_f32 v27, v27, v42
  v_fmac_f32 v27, v43, v163
  v_cvt_pk_bf16_f32 v24, v24, v25
  v_cvt_pk_bf16_f32 v25, v26, v27
  ds_write_b32 v28, v24 offset:3072
  ds_write_b32 v29, v25 offset:3072
  s_branch L_A_att
L_A_vp:
  s_mov_b32 exec_hi, 0
  s_nop 4
  v_lshlrev_b32 v30, 2, v3
  s_add_u32 s36, s40, 0
  s_lshl_b32 s36, s36, 4
  v_add_u32 v30, s36, v30
  s_mov_b32 s36, 160768
  v_lshl_add_u32 v33, v30, 2, s36
  ds_read_b128 v[160:163], v33
  s_mov_b32 s36, 57
  v_mul_u32_u24 v31, s36, v30
  v_lshrrev_b32 v31, 10, v31
  s_movk_i32 s36, 6712
  v_mul_u32_u24 v28, s36, v31
  v_lshl_add_u32 v28, v30, 2, v28
  v_mul_u32_u24 v32, 0x50, v4
  s_mov_b32 s36, 69632
  v_add3_u32 v28, v28, v32, s36
  v_add_u32 v30, 2, v30
  s_mov_b32 s36, 57
  v_mul_u32_u24 v31, s36, v30
  v_lshrrev_b32 v31, 10, v31
  s_movk_i32 s36, 6712
  v_mul_u32_u24 v29, s36, v31
  v_lshl_add_u32 v29, v30, 2, v29
  v_mul_u32_u24 v32, 0x50, v4
  s_mov_b32 s36, 69632
  v_add3_u32 v29, v29, v32, s36
  s_mov_b32 s36, 0x05040100
  s_mov_b32 s37, 0x07060302
  s_waitcnt lgkmcnt(0)
  v_mul_f32 v8, v8, v34
  v_fmac_f32 v8, v35, v160
  v_mul_f32 v9, v9, v34
  v_fmac_f32 v9, v35, v161
  v_mul_f32 v10, v10, v34
  v_fmac_f32 v10, v35, v162
  v_mul_f32 v11, v11, v34
  v_fmac_f32 v11, v35, v163
  v_cvt_pk_bf16_f32 v8, v8, v9
  v_cvt_pk_bf16_f32 v9, v10, v11
  v_mul_f32 v12, v12, v36
  v_fmac_f32 v12, v37, v160
  v_mul_f32 v13, v13, v36
  v_fmac_f32 v13, v37, v161
  v_mul_f32 v14, v14, v36
  v_fmac_f32 v14, v37, v162
  v_mul_f32 v15, v15, v36
  v_fmac_f32 v15, v37, v163
  v_cvt_pk_bf16_f32 v12, v12, v13
  v_cvt_pk_bf16_f32 v13, v14, v15
  v_mul_f32 v16, v16, v38
  v_fmac_f32 v16, v39, v160
  v_mul_f32 v17, v17, v38
  v_fmac_f32 v17, v39, v161
  v_mul_f32 v18, v18, v38
  v_fmac_f32 v18, v39, v162
  v_mul_f32 v19, v19, v38
  v_fmac_f32 v19, v39, v163
  v_cvt_pk_bf16_f32 v16, v16, v17
  v_cvt_pk_bf16_f32 v17, v18, v19
  v_mul_f32 v20, v20, v40
  v_fmac_f32 v20, v41, v160
  v_mul_f32 v21, v21, v40
  v_fmac_f32 v21, v41, v161
  v_mul_f32 v22, v22, v40
  v_fmac_f32 v22, v41, v162
  v_mul_f32 v23, v23, v40
  v_fmac_f32 v23, v41, v163
  v_cvt_pk_bf16_f32 v20, v20, v21
  v_cvt_pk_bf16_f32 v21, v22, v23
  v_mul_f32 v24, v24, v42
  v_fmac_f32 v24, v43, v160
  v_mul_f32 v25, v25, v42
  v_fmac_f32 v25, v43, v161
  v_mul_f32 v26, v26, v42
  v_fmac_f32 v26, v43, v162
  v_mul_f32 v27, v27, v42
  v_fmac_f32 v27, v43, v163
  v_cvt_pk_bf16_f32 v24, v24, v25
  v_cvt_pk_bf16_f32 v25, v26, v27
  v_mov_b32_dpp v10, v8 row_shr:2 row_mask:0xf bank_mask:0xf
  v_mov_b32_dpp v11, v9 row_shr:2 row_mask:0xf bank_mask:0xf
  v_perm_b32 v44, v10, v8, s36
  v_perm_b32 v45, v10, v8, s37
  v_perm_b32 v46, v11, v9, s36
  v_perm_b32 v47, v11, v9, s37
  ds_write_b64 v28, v[44:45] offset:0
  ds_write_b64 v29, v[46:47] offset:0
  v_mov_b32_dpp v14, v8 row_shl:14 row_mask:0xf bank_mask:0xf
  v_mov_b32_dpp v15, v9 row_shl:14 row_mask:0xf bank_mask:0xf
  v_mov_b32_dpp v14, v12 row_shr:2 row_mask:0xf bank_mask:0xf
  v_mov_b32_dpp v15, v13 row_shr:2 row_mask:0xf bank_mask:0xf
  v_perm_b32 v48, v14, v12, s36
  v_perm_b32 v49, v14, v12, s37
  v_perm_b32 v50, v15, v13, s36
  v_perm_b32 v51, v15, v13, s37
  ds_write_b64 v28, v[48:49] offset:1280
  ds_write_b64 v29, v[50:51] offset:1280
  v_mov_b32_dpp v18, v12 row_shl:14 row_mask:0xf bank_mask:0xf
  v_mov_b32_dpp v19, v13 row_shl:14 row_mask:0xf bank_mask:0xf
  v_mov_b32_dpp v18, v16 row_shr:2 row_mask:0xf bank_mask:0xf
  v_mov_b32_dpp v19, v17 row_shr:2 row_mask:0xf bank_mask:0xf
  v_perm_b32 v44, v18, v16, s36
  v_perm_b32 v45, v18, v16, s37
  v_perm_b32 v46, v19, v17, s36
  v_perm_b32 v47, v19, v17, s37
  ds_write_b64 v28, v[44:45] offset:2560
  ds_write_b64 v29, v[46:47] offset:2560
  v_mov_b32_dpp v22, v16 row_shl:14 row_mask:0xf bank_mask:0xf
  v_mov_b32_dpp v23, v17 row_shl:14 row_mask:0xf bank_mask:0xf
  v_mov_b32_dpp v22, v20 row_shr:2 row_mask:0xf bank_mask:0xf
  v_mov_b32_dpp v23, v21 row_shr:2 row_mask:0xf bank_mask:0xf
  v_perm_b32 v48, v22, v20, s36
  v_perm_b32 v49, v22, v20, s37
  v_perm_b32 v50, v23, v21, s36
  v_perm_b32 v51, v23, v21, s37
  ds_write_b64 v28, v[48:49] offset:3840
  ds_write_b64 v29, v[50:51] offset:3840
  v_mov_b32_dpp v26, v20 row_shl:14 row_mask:0xf bank_mask:0xf
  v_mov_b32_dpp v27, v21 row_shl:14 row_mask:0xf bank_mask:0xf
  v_mov_b32_dpp v26, v24 row_shr:2 row_mask:0xf bank_mask:0xf
  v_mov_b32_dpp v27, v25 row_shr:2 row_mask:0xf bank_mask:0xf
  v_perm_b32 v44, v26, v24, s36
  v_perm_b32 v45, v26, v24, s37
  v_perm_b32 v46, v27, v25, s36
  v_perm_b32 v47, v27, v25, s37
  ds_write_b64 v28, v[44:45] offset:5120
  ds_write_b64 v29, v[46:47] offset:5120
  s_mov_b64 exec, -1
  s_branch L_A_att
L_A_free:
  s_cmp_eq_u32 s3, 9
  s_cbranch_scc1 L_A_fr2
  s_add_u32 s36, s27, 96
  v_mov_b32 v8, s36
L_lw_20:
  ds_read_b32 v9, v8
  s_waitcnt lgkmcnt(0)
  v_readfirstlane_b32 s36, v9
  s_nop 3
  s_cmp_ge_u32 s36, 4
  s_cbranch_scc1 L_lw_20_ok
  s_sleep 2
  s_branch L_lw_20
L_lw_20_ok:
  s_add_u32 s36, s27, 100
  v_mov_b32 v8, s36
L_lw_21:
  ds_read_b32 v9, v8
  s_waitcnt lgkmcnt(0)
  v_readfirstlane_b32 s36, v9
  s_nop 3
  s_cmp_ge_u32 s36, 4
  s_cbranch_scc1 L_lw_21_ok
  s_sleep 2
  s_branch L_lw_21
L_lw_21_ok:
  s_add_u32 s36, s27, 104
  v_mov_b32 v8, s36
L_lw_22:
  ds_read_b32 v9, v8
  s_waitcnt lgkmcnt(0)
  v_readfirstlane_b32 s36, v9
  s_nop 3
  s_cmp_ge_u32 s36, 4
  s_cbranch_scc1 L_lw_22_ok
  s_sleep 2
  s_branch L_lw_22
L_lw_22_ok:
  s_cmp_eq_u32 s3, 8
  s_cbranch_scc1 L_A_combq
  s_cmp_eq_u32 s3, 11
  s_cbranch_scc1 L_A_combh
  v_lshlrev_b32 v6, 3, v1
  v_add_u32 v7, 92160, v6
  ds_read_b64 v[8:9], v7 offset:0
  ds_read_b64 v[10:11], v7 offset:512
  ds_read_b64 v[12:13], v7 offset:1024
  ds_read_b64 v[14:15], v7 offset:1536
  ds_read_b64 v[16:17], v7 offset:2048
  ds_read_b64 v[18:19], v7 offset:2560
  ds_read_b64 v[20:21], v7 offset:3072
  ds_read_b64 v[22:23], v7 offset:3584
  ds_read_b64 v[24:25], v7 offset:4096
  ds_read_b64 v[26:27], v7 offset:4608
  ds_read_b64 v[28:29], v7 offset:5120
  ds_read_b64 v[30:31], v7 offset:5632
  s_waitcnt lgkmcnt(0)
  v_add_f32 v8, v8, v30
  v_add_f32 v9, v9, v31
  v_add_f32 v10, v10, v28
  v_add_f32 v11, v11, v29
  v_add_f32 v12, v12, v26
  v_add_f32 v13, v13, v27
  v_add_f32 v14, v14, v24
  v_add_f32 v15, v15, v25
  v_add_f32 v16, v16, v22
  v_add_f32 v17, v17, v23
  v_add_f32 v18, v18, v20
  v_add_f32 v19, v19, v21
  v_add_f32 v8, v8, v18
  v_add_f32 v9, v9, v19
  v_add_f32 v10, v10, v16
  v_add_f32 v11, v11, v17
  v_add_f32 v12, v12, v14
  v_add_f32 v13, v13, v15
  v_add_f32 v8, v8, v12
  v_add_f32 v9, v9, v13
  v_add_f32 v8, v8, v10
  v_add_f32 v9, v9, v11
  v_mul_f32 v8, 0x3ae38e39, v8
  v_mul_f32 v9, 0x3ae38e39, v9
  v_fma_f32 v9, -v8, v8, v9
  v_max_f32 v9, 0, v9
  v_add_f32 v9, 0x3727c5ac, v9
  v_rsq_f32 v10, v9
  v_add_u32 v6, 151168, v6
  v_mul_f32 v11, v8, v10
  v_sub_f32 v11, 0, v11
  ds_write_b64 v6, v[10:11]
  s_waitcnt lgkmcnt(0)
  s_branch L_A_combd
L_A_combh:
  v_lshlrev_b32 v6, 3, v1
  v_add_u32 v7, 98304, v6
  ds_read_b64 v[8:9], v7 offset:0
  ds_read_b64 v[10:11], v7 offset:512
  ds_read_b64 v[12:13], v7 offset:1024
  ds_read_b64 v[14:15], v7 offset:1536
  ds_read_b64 v[16:17], v7 offset:2048
  ds_read_b64 v[18:19], v7 offset:2560
  ds_read_b64 v[20:21], v7 offset:3072
  ds_read_b64 v[22:23], v7 offset:3584
  ds_read_b64 v[24:25], v7 offset:4096
  ds_read_b64 v[26:27], v7 offset:4608
  ds_read_b64 v[28:29], v7 offset:5120
  ds_read_b64 v[30:31], v7 offset:5632
  s_waitcnt lgkmcnt(0)
  v_add_f32 v8, v8, v30
  v_add_f32 v9, v9, v31
  v_add_f32 v10, v10, v28
  v_add_f32 v11, v11, v29
  v_add_f32 v12, v12, v26
  v_add_f32 v13, v13, v27
  v_add_f32 v14, v14, v24
  v_add_f32 v15, v15, v25
  v_add_f32 v16, v16, v22
  v_add_f32 v17, v17, v23
  v_add_f32 v18, v18, v20
  v_add_f32 v19, v19, v21
  v_add_f32 v8, v8, v18
  v_add_f32 v9, v9, v19
  v_add_f32 v10, v10, v16
  v_add_f32 v11, v11, v17
  v_add_f32 v12, v12, v14
  v_add_f32 v13, v13, v15
  v_add_f32 v8, v8, v12
  v_add_f32 v9, v9, v13
  v_add_f32 v8, v8, v10
  v_add_f32 v9, v9, v11
  v_mov_b32 v10, v8
  v_mov_b32 v11, v9
  s_nop 1
  v_permlane32_swap_b32 v8, v10
  v_permlane32_swap_b32 v9, v11
  s_nop 1
  v_add_f32 v8, v8, v10
  v_add_f32 v9, v9, v11
  v_mov_b32 v10, v8
  v_mov_b32 v11, v9
  s_nop 1
  v_permlane16_swap_b32 v8, v10
  v_permlane16_swap_b32 v9, v11
  s_nop 1
  v_add_f32 v8, v8, v10
  v_add_f32 v9, v9, v11
  v_lshlrev_b32 v6, 3, v4
  v_mul_f32 v8, 0x3ae38e39, v8
  v_mul_f32 v9, 0x3ae38e39, v9
  v_fma_f32 v9, -v8, v8, v9
  v_max_f32 v9, 0, v9
  v_add_f32 v9, 0x3727c5ac, v9
  v_rsq_f32 v10, v9
  v_add_u32 v6, 151040, v6
  v_mul_f32 v11, v8, v10
  v_sub_f32 v11, 0, v11
  ds_write_b64 v6, v[10:11]
  s_waitcnt lgkmcnt(0)
  s_branch L_A_combd
L_A_combq:
  s_cmp_lg_u32 s22, 0
  s_cbranch_scc1 L_A_combd
  v_min_u32 v7, 53, v1
  s_mov_b32 s44, 57
  v_mul_u32_u24 v6, s44, v7
  v_lshrrev_b32 v6, 10, v6
  v_mul_u32_u24 v6, 0x7e0, v6
  v_lshl_add_u32 v6, v7, 4, v6
  s_mul_i32 s42, s30, 288
  s_add_u32 s42, s42, 0xea0000
  buffer_load_dwordx4 v[8:11], v6, s[8:11], s42 offen sc1
  s_add_u32 s42, s42, 6912
  buffer_load_dwordx4 v[12:15], v6, s[8:11], s42 offen sc1
  s_add_u32 s42, s42, 6912
  buffer_load_dwordx4 v[16:19], v6, s[8:11], s42 offen sc1
  s_add_u32 s42, s42, 6912
  buffer_load_dwordx4 v[20:23], v6, s[8:11], s42 offen sc1
  s_add_u32 s42, s42, 6912
  buffer_load_dwordx4 v[24:27], v6, s[8:11], s42 offen sc1
  s_add_u32 s42, s42, 6912
  buffer_load_dwordx4 v[28:31], v6, s[8:11], s42 offen sc1
  s_add_u32 s42, s42, 6912
  buffer_load_dwordx4 v[32:35], v6, s[8:11], s42 offen sc1
  s_add_u32 s42, s42, 6912
  buffer_load_dwordx4 v[36:39], v6, s[8:11], s42 offen sc1
  s_add_u32 s42, s42, 6912
  buffer_load_dwordx4 v[40:43], v6, s[8:11], s42 offen sc1
  s_add_u32 s42, s42, 6912
  buffer_load_dwordx4 v[44:47], v6, s[8:11], s42 offen sc1
  s_add_u32 s42, s42, 6912
  buffer_load_dwordx4 v[48:51], v6, s[8:11], s42 offen sc1
  s_add_u32 s42, s42, 6912
  buffer_load_dwordx4 v[52:55], v6, s[8:11], s42 offen sc1
  s_add_u32 s42, s42, 6912
  buffer_load_dwordx4 v[56:59], v6, s[8:11], s42 offen sc1
  s_add_u32 s42, s42, 6912
  buffer_load_dwordx4 v[60:63], v6, s[8:11], s42 offen sc1
  s_add_u32 s42, s42, 6912
  buffer_load_dwordx4 v[64:67], v6, s[8:11], s42 offen sc1
  s_add_u32 s42, s42, 6912
  buffer_load_dwordx4 v[68:71], v6, s[8:11], s42 offen sc1
  s_add_u32 s42, s42, 6912
  buffer_load_dwordx4 v[72:75], v6, s[8:11], s42 offen sc1
  s_add_u32 s42, s42, 6912
  buffer_load_dwordx4 v[76:79], v6, s[8:11], s42 offen sc1
  v_add_u32 v6, 160768, v2
  s_waitcnt vmcnt(0)
  v_add_f32 v8, v8, v12
  v_add_f32 v9, v9, v13
  v_add_f32 v10, v10, v14
  v_add_f32 v11, v11, v15
  v_add_f32 v8, v8, v16
  v_add_f32 v9, v9, v17
  v_add_f32 v10, v10, v18
  v_add_f32 v11, v11, v19
  v_add_f32 v8, v8, v20
  v_add_f32 v9, v9, v21
  v_add_f32 v10, v10, v22
  v_add_f32 v11, v11, v23
  v_add_f32 v8, v8, v24
  v_add_f32 v9, v9, v25
  v_add_f32 v10, v10, v26
  v_add_f32 v11, v11, v27
  v_add_f32 v8, v8, v28
  v_add_f32 v9, v9, v29
  v_add_f32 v10, v10, v30
  v_add_f32 v11, v11, v31
  v_add_f32 v8, v8, v32
  v_add_f32 v9, v9, v33
  v_add_f32 v10, v10, v34
  v_add_f32 v11, v11, v35
  v_add_f32 v8, v8, v36
  v_add_f32 v9, v9, v37
  v_add_f32 v10, v10, v38
  v_add_f32 v11, v11, v39
  v_add_f32 v8, v8, v40
  v_add_f32 v9, v9, v41
  v_add_f32 v10, v10, v42
  v_add_f32 v11, v11, v43
  v_add_f32 v8, v8, v44
  v_add_f32 v9, v9, v45
  v_add_f32 v10, v10, v46
  v_add_f32 v11, v11, v47
  v_add_f32 v8, v8, v48
  v_add_f32 v9, v9, v49
  v_add_f32 v10, v10, v50
  v_add_f32 v11, v11, v51
  v_add_f32 v8, v8, v52
  v_add_f32 v9, v9, v53
  v_add_f32 v10, v10, v54
  v_add_f32 v11, v11, v55
  v_add_f32 v8, v8, v56
  v_add_f32 v9, v9, v57
  v_add_f32 v10, v10, v58
  v_add_f32 v11, v11, v59
  v_add_f32 v8, v8, v60
  v_add_f32 v9, v9, v61
  v_add_f32 v10, v10, v62
  v_add_f32 v11, v11, v63
  v_add_f32 v8, v8, v64
  v_add_f32 v9, v9, v65
  v_add_f32 v10, v10, v66
  v_add_f32 v11, v11, v67
  v_add_f32 v8, v8, v68
  v_add_f32 v9, v9, v69
  v_add_f32 v10, v10, v70
  v_add_f32 v11, v11, v71
  v_add_f32 v8, v8, v72
  v_add_f32 v9, v9, v73
  v_add_f32 v10, v10, v74
  v_add_f32 v11, v11, v75
  v_add_f32 v8, v8, v76
  v_add_f32 v9, v9, v77
  v_add_f32 v10, v10, v78
  v_add_f32 v11, v11, v79
  ds_write_b128 v6, v[8:11]
  s_waitcnt lgkmcnt(0)
L_A_combd:
  s_add_u32 s36, s27, 0
  v_mov_b32 v8, s36
  v_mov_b32 v9, 1
  s_mov_b64 exec, 1
  ds_add_u32 v8, v9
  s_mov_b64 exec, -1
  s_waitcnt lgkmcnt(0)
  s_branch L_A_att
L_A_fr2:
  s_cmp_lg_u32 s22, 0
  s_cbranch_scc1 L_A_att
  s_add_u32 s36, s27, 96
  v_mov_b32 v8, s36
L_lw_23:
  ds_read_b32 v9, v8
  s_waitcnt lgkmcnt(0)
  v_readfirstlane_b32 s36, v9
  s_nop 3
  s_cmp_ge_u32 s36, 4
  s_cbranch_scc1 L_lw_23_ok
  s_sleep 2
  s_branch L_lw_23
L_lw_23_ok:
  s_add_u32 s36, s27, 100
  v_mov_b32 v8, s36
L_lw_24:
  ds_read_b32 v9, v8
  s_waitcnt lgkmcnt(0)
  v_readfirstlane_b32 s36, v9
  s_nop 3
  s_cmp_ge_u32 s36, 4
  s_cbranch_scc1 L_lw_24_ok
  s_sleep 2
  s_branch L_lw_24
L_lw_24_ok:
  s_add_u32 s36, s27, 104
  v_mov_b32 v8, s36
L_lw_25:
  ds_read_b32 v9, v8
  s_waitcnt lgkmcnt(0)
  v_readfirstlane_b32 s36, v9
  s_nop 3
  s_cmp_ge_u32 s36, 4
  s_cbranch_scc1 L_lw_25_ok
  s_sleep 2
  s_branch L_lw_25
L_lw_25_ok:
  s_lshl_b32 s37, s32, 7
  s_add_u32 s37, s37, 0xf85c00
  v_lshlrev_b32 v8, 10, v1
  s_mov_b32 exec_lo, 0xffffffff
  s_mov_b32 exec_hi, 0xf
  s_mov_b32 s38, 0x20000
L_aw_26:
  v_mov_b32 v10, 0
  v_mov_b32 v11, 0
  buffer_atomic_or_x2 v[10:11], v8, s[8:11], s37 offen sc0 sc1
  s_waitcnt vmcnt(0)
  v_cmp_ne_u64 vcc, s[62:63], v[10:11]
  s_sub_u32 s38, s38, 1
  s_nop 3
  s_cbranch_vccz L_aw_26_ok
  s_cmp_eq_u32 s38, 0
  s_cbranch_scc1 L_aw_26_ok
  s_sleep 24
  s_branch L_aw_26
L_aw_26_ok:
  s_mov_b64 exec, -1
L_A_att:
  s_waitcnt lgkmcnt(0)
  s_barrier
  s_cmp_ge_u32 s3, 8
  s_cbranch_scc1 L_A_cs
  s_lshl_b32 s41, s3, 3
  v_and_b32 v5, 7, v1
  v_add_u32 v5, s41, v5
  v_lshrrev_b32 v6, 5, v1
  v_bfe_u32 v166, v1, 3, 2
  v_mul_u32_u24 v7, 48, v5
  v_mul_u32_u24 v86, 0xf80, v166
  s_mov_b32 s36, 92928
  v_add3_u32 v7, v7, v86, s36
  v_mul_u32_u24 v86, 0x180, v6
  v_sub_u32 v86, v7, v86
  v_lshlrev_b32 v164, 3, v6
  v_sub_u32 v164, v5, v164
  v_add_u32 v87, 12, v164
  v_mul_u32_u24 v87, 0x50, v87
  v_mul_u32_u24 v165, 0x1a80, v166
  s_mov_b32 s36, 123904
  v_add3_u32 v87, v87, v165, s36
  ds_read_b128 v[8:11], v7 offset:0
  ds_read_b128 v[12:15], v7 offset:16
  ds_read_b128 v[16:19], v7 offset:32
  ds_read_b128 v[20:23], v86 offset:15872
  ds_read_b128 v[24:27], v86 offset:15888
  ds_read_b128 v[28:31], v86 offset:15904
  ds_read_b128 v[32:35], v86 offset:15776
  ds_read_b128 v[36:39], v86 offset:15792
  ds_read_b128 v[40:43], v86 offset:15808
  ds_read_b128 v[44:47], v86 offset:15680
  ds_read_b128 v[48:51], v86 offset:15696
  ds_read_b128 v[52:55], v86 offset:15712
  ds_read_b128 v[56:59], v86 offset:15584
  ds_read_b128 v[60:63], v86 offset:15600
  ds_read_b128 v[64:67], v86 offset:15616
  s_lshl_b32 s36, s29, 6
  v_add_u32 v164, s36, v164
  v_cmp_le_i32 s[50:51], 0, v164
  v_cmp_le_i32 s[52:53], 2, v164
  v_cmp_le_i32 s[54:55], 4, v164
  v_cmp_le_i32 s[56:57], 6, v164
  s_waitcnt lgkmcnt(6)
  v_dot2_f32_bf16 v160, v8, v20, 0
  v_dot2_f32_bf16 v161, v8, v32, 0
  v_dot2_f32_bf16 v160, v9, v21, v160
  v_dot2_f32_bf16 v161, v9, v33, v161
  v_dot2_f32_bf16 v160, v10, v22, v160
  v_dot2_f32_bf16 v161, v10, v34, v161
  v_dot2_f32_bf16 v160, v11, v23, v160
  v_dot2_f32_bf16 v161, v11, v35, v161
  v_dot2_f32_bf16 v160, v12, v24, v160
  v_dot2_f32_bf16 v161, v12, v36, v161
  v_dot2_f32_bf16 v160, v13, v25, v160
  v_dot2_f32_bf16 v161, v13, v37, v161
  v_dot2_f32_bf16 v160, v14, v26, v160
  v_dot2_f32_bf16 v161, v14, v38, v161
  v_dot2_f32_bf16 v160, v15, v27, v160
  v_dot2_f32_bf16 v161, v15, v39, v161
  v_dot2_f32_bf16 v160, v16, v28, v160
  v_dot2_f32_bf16 v161, v16, v40, v161
  ds_read_b128 v[20:23], v87 offset:320
  ds_read_b128 v[24:27], v87 offset:336
  ds_read_b128 v[28:31], v87 offset:352
  ds_read_b128 v[32:35], v87 offset:368
  ds_read_b128 v[36:39], v87 offset:384
  s_waitcnt lgkmcnt(5)
  v_dot2_f32_bf16 v162, v8, v44, 0
  v_dot2_f32_bf16 v163, v8, v56, 0
  v_dot2_f32_bf16 v162, v9, v45, v162
  v_dot2_f32_bf16 v163, v9, v57, v163
  v_dot2_f32_bf16 v162, v10, v46, v162
  v_dot2_f32_bf16 v163, v10, v58, v163
  v_dot2_f32_bf16 v162, v11, v47, v162
  v_dot2_f32_bf16 v163, v11, v59, v163
  v_dot2_f32_bf16 v162, v12, v48, v162
  v_dot2_f32_bf16 v163, v12, v60, v163
  v_dot2_f32_bf16 v162, v13, v49, v162
  v_dot2_f32_bf16 v163, v13, v61, v163
  v_dot2_f32_bf16 v162, v14, v50, v162
  v_dot2_f32_bf16 v163, v14, v62, v163
  v_dot2_f32_bf16 v162, v15, v51, v162
  v_dot2_f32_bf16 v163, v15, v63, v163
  v_dot2_f32_bf16 v162, v16, v52, v162
  v_dot2_f32_bf16 v163, v16, v64, v163
  ds_read_b128 v[44:47], v87 offset:0
  ds_read_b128 v[48:51], v87 offset:16
  ds_read_b128 v[52:55], v87 offset:32
  ds_read_b128 v[56:59], v87 offset:48
  ds_read_b128 v[60:63], v87 offset:64
  v_mov_b32 v164, 0xf149f2ca
  s_nop 1
  v_mul_f32 v160, 0x3eae1a93, v160
  v_mul_f32 v161, 0x3eae1a93, v161
  v_mul_f32 v162, 0x3eae1a93, v162
  v_mul_f32 v163, 0x3eae1a93, v163
  v_cndmask_b32 v160, v164, v160, s[50:51]
  v_cndmask_b32 v161, v164, v161, s[52:53]
  v_cndmask_b32 v162, v164, v162, s[54:55]
  v_cndmask_b32 v163, v164, v163, s[56:57]
  v_max3_f32 v164, v160, v161, v162
  v_max_f32 v164, v164, v163
  v_mov_b32 v165, v164
  s_nop 1
  v_permlane32_swap_b32 v164, v165
  s_nop 1
  v_max_f32 v164, v164, v165
  v_sub_f32 v160, v160, v164
  v_sub_f32 v161, v161, v164
  v_sub_f32 v162, v162, v164
  v_sub_f32 v163, v163, v164
  v_exp_f32 v160, v160
  v_exp_f32 v161, v161
  v_exp_f32 v162, v162
  v_exp_f32 v163, v163
  s_nop 0
  v_cvt_pk_bf16_f32 v160, v160, v161
  v_cvt_pk_bf16_f32 v162, v162, v163
  s_mov_b32 s36, 0x3f803f80
  v_dot2_f32_bf16 v164, v160, s36, 0
  v_dot2_f32_bf16 v164, v162, s36, v164
  s_waitcnt lgkmcnt(5)
  v_dot2_f32_bf16 v68, v20, v160, 0
  v_dot2_f32_bf16 v69, v21, v160, 0
  v_dot2_f32_bf16 v70, v22, v160, 0
  v_dot2_f32_bf16 v71, v23, v160, 0
  v_dot2_f32_bf16 v72, v24, v160, 0
  v_dot2_f32_bf16 v73, v25, v160, 0
  v_dot2_f32_bf16 v74, v26, v160, 0
  v_dot2_f32_bf16 v75, v27, v160, 0
  v_dot2_f32_bf16 v76, v28, v160, 0
  v_dot2_f32_bf16 v77, v29, v160, 0
  v_dot2_f32_bf16 v78, v30, v160, 0
  v_dot2_f32_bf16 v79, v31, v160, 0
  v_dot2_f32_bf16 v80, v32, v160, 0
  v_dot2_f32_bf16 v81, v33, v160, 0
  v_dot2_f32_bf16 v82, v34, v160, 0
  v_dot2_f32_bf16 v83, v35, v160, 0
  v_dot2_f32_bf16 v84, v36, v160, 0
  v_dot2_f32_bf16 v85, v37, v160, 0
  v_mov_b32 v165, v164
  s_waitcnt lgkmcnt(0)
  v_dot2_f32_bf16 v68, v44, v162, v68
  v_dot2_f32_bf16 v69, v45, v162, v69
  v_dot2_f32_bf16 v70, v46, v162, v70
  v_dot2_f32_bf16 v71, v47, v162, v71
  v_dot2_f32_bf16 v72, v48, v162, v72
  v_dot2_f32_bf16 v73, v49, v162, v73
  v_dot2_f32_bf16 v74, v50, v162, v74
  v_dot2_f32_bf16 v75, v51, v162, v75
  v_dot2_f32_bf16 v76, v52, v162, v76
  v_dot2_f32_bf16 v77, v53, v162, v77
  v_dot2_f32_bf16 v78, v54, v162, v78
  v_dot2_f32_bf16 v79, v55, v162, v79
  v_dot2_f32_bf16 v80, v56, v162, v80
  v_dot2_f32_bf16 v81, v57, v162, v81
  v_dot2_f32_bf16 v82, v58, v162, v82
  v_dot2_f32_bf16 v83, v59, v162, v83
  v_dot2_f32_bf16 v84, v60, v162, v84
  v_dot2_f32_bf16 v85, v61, v162, v85
  v_permlane32_swap_b32 v164, v165
  s_nop 1
  v_add_f32 v164, v164, v165
  v_rcp_f32 v164, v164
  v_permlane32_swap_b32 v68, v76
  v_permlane32_swap_b32 v69, v77
  v_permlane32_swap_b32 v70, v78
  v_permlane32_swap_b32 v71, v79
  v_permlane32_swap_b32 v72, v80
  v_permlane32_swap_b32 v73, v81
  v_permlane32_swap_b32 v74, v82
  v_permlane32_swap_b32 v75, v83
  v_permlane32_swap_b32 v84, v85
  s_nop 1
  v_add_f32 v68, v68, v76
  v_add_f32 v69, v69, v77
  v_add_f32 v70, v70, v78
  v_add_f32 v71, v71, v79
  v_add_f32 v72, v72, v80
  v_add_f32 v73, v73, v81
  v_add_f32 v74, v74, v82
  v_add_f32 v75, v75, v83
  v_add_f32 v84, v84, v85
  v_mul_f32 v68, v68, v164
  v_mul_f32 v69, v69, v164
  v_mul_f32 v70, v70, v164
  v_mul_f32 v71, v71, v164
  v_mul_f32 v72, v72, v164
  v_mul_f32 v73, v73, v164
  v_mul_f32 v74, v74, v164
  v_mul_f32 v75, v75, v164
  v_mul_f32 v84, v84, v164
  v_cvt_pk_bf16_f32 v12, v84, v84
  v_lshlrev_b32 v5, 4, v5
  v_lshl_add_u32 v166, v166, 1, v6
  v_lshl_add_u32 v86, v166, 1, v5
  v_add_u32 v86, 151680, v86
  ds_write_b16 v86, v12
  v_add_u32 v87, 151680, v5
  v_cvt_pk_bf16_f32 v8, v68, v69
  v_cvt_pk_bf16_f32 v9, v70, v71
  v_cvt_pk_bf16_f32 v10, v72, v73
  v_cvt_pk_bf16_f32 v11, v74, v75
  s_waitcnt lgkmcnt(0)
  ds_read_b128 v[12:15], v87
  v_lshl_add_u32 v7, v166, 10, v5
  s_mul_i32 s36, s30, 9216
  s_mul_i32 s37, s29, 73728
  s_add_u32 s36, s36, s37
  s_add_u32 s36, s36, s24
  s_add_u32 s38, s36, 8192
  buffer_store_dwordx4 v[8:11], v7, s[8:11], s36 offen sc1
  s_mov_b64 exec, 0xff
  s_waitcnt lgkmcnt(0)
  buffer_store_dwordx4 v[12:15], v5, s[8:11], s38 offen sc1
  s_mov_b64 exec, -1
  s_add_u32 s36, s27, 4
  s_lshl_b32 s37, s29, 10
  s_lshl_b32 s38, s30, 7
  s_add_u32 s37, s37, s38
  s_add_u32 s37, s37, s28
  s_add_u32 s37, s37, 0
  s_waitcnt vmcnt(0)
  v_mov_b32 v20, s36
  v_mov_b32 v21, 1
  s_mov_b64 exec, 1
  ds_add_rtn_u32 v20, v20, v21
  s_waitcnt lgkmcnt(0)
  v_readfirstlane_b32 s36, v20
  v_mov_b32 v20, s62
  v_mov_b32 v21, s63
  v_lshlrev_b32 v22, 13, v1
  s_nop 0
  s_cmp_lg_u32 s36, 7
  s_cbranch_scc1 L_pub_27
  buffer_store_dwordx2 v[20:21], v22, s[8:11], s37 offen sc1
L_pub_27:
  s_mov_b64 exec, -1
  buffer_load_dwordx4 v[88:91], v2, s[8:11], s48 offen offset:0 sc1
  buffer_load_dwordx4 v[92:95], v2, s[8:11], s48 offen offset:1024 sc1
  buffer_load_dwordx4 v[96:99], v2, s[8:11], s48 offen offset:2048 sc1
  s_add_u32 s48, s48, 3072
  s_cmp_eq_u32 s48, s49
  s_cselect_b32 s48, s47, s48
  buffer_load_dwordx4 v[100:103], v2, s[8:11], s48 offen offset:0 sc1
  buffer_load_dwordx4 v[104:107], v2, s[8:11], s48 offen offset:1024 sc1
  buffer_load_dwordx4 v[108:111], v2, s[8:11], s48 offen offset:2048 sc1
  s_add_u32 s48, s48, 3072
  s_cmp_eq_u32 s48, s49
  s_cselect_b32 s48, s47, s48
  s_branch L_A_end
L_A_cs:
  s_cmp_ge_u32 s3, 10
  s_cbranch_scc1 L_A_nb
  buffer_load_dwordx4 v[124:127], v2, s[8:11], s58 offen offset:0 sc1
  buffer_load_dwordx4 v[128:131], v2, s[8:11], s58 offen offset:1024 sc1
  buffer_load_dwordx4 v[132:135], v2, s[8:11], s58 offen offset:2048 sc1
  buffer_load_dwordx4 v[136:139], v2, s[8:11], s58 offen offset:3072 sc1
  s_add_u32 s58, s58, 4096
  buffer_load_dwordx4 v[140:143], v2, s[8:11], s58 offen offset:0 sc1
  buffer_load_dwordx4 v[144:147], v2, s[8:11], s58 offen offset:1024 sc1
  buffer_load_dwordx4 v[148:151], v2, s[8:11], s58 offen offset:2048 sc1
  buffer_load_dwordx4 v[152:155], v2, s[8:11], s58 offen offset:3072 sc1
  s_add_u32 s58, s58, 4096
  buffer_load_dwordx4 v[156:159], v2, s[8:11], s58 offen offset:0 sc1
L_A_nb:
  buffer_load_dwordx4 v[88:91], v2, s[8:11], s48 offen offset:0 sc1
  buffer_load_dwordx4 v[92:95], v2, s[8:11], s48 offen offset:1024 sc1
  buffer_load_dwordx4 v[96:99], v2, s[8:11], s48 offen offset:2048 sc1
  s_add_u32 s48, s48, 3072
  s_cmp_eq_u32 s48, s49
  s_cselect_b32 s48, s47, s48
  buffer_load_dwordx4 v[100:103], v2, s[8:11], s48 offen offset:0 sc1
  buffer_load_dwordx4 v[104:107], v2, s[8:11], s48 offen offset:1024 sc1
  buffer_load_dwordx4 v[108:111], v2, s[8:11], s48 offen offset:2048 sc1
  s_add_u32 s48, s48, 3072
  s_cmp_eq_u32 s48, s49
  s_cselect_b32 s48, s47, s48
  s_cmp_lg_u32 s22, 0
  s_cbranch_scc1 L_A_end
  s_cmp_eq_u32 s61, 3
  s_cbranch_scc1 L_A_b1
  s_mul_i32 s36, s32, 2304
  s_lshl_b32 s37, s61, 10
  s_add_u32 s36, s36, 0xe40000
  v_add_u32 v6, s37, v2
  v_min_u32 v6, 0x8f0, v6
  buffer_load_dwordx4 v[8:11], v6, s[8:11], s36 offen sc1
  s_add_u32 s36, s36, 18432
  buffer_load_dwordx4 v[12:15], v6, s[8:11], s36 offen sc1
  s_add_u32 s36, s36, 18432
  buffer_load_dwordx4 v[16:19], v6, s[8:11], s36 offen sc1
  s_add_u32 s36, s36, 18432
  buffer_load_dwordx4 v[20:23], v6, s[8:11], s36 offen sc1
  s_add_u32 s36, s36, 18432
  buffer_load_dwordx4 v[24:27], v6, s[8:11], s36 offen sc1
  s_add_u32 s36, s36, 18432
  buffer_load_dwordx4 v[28:31], v6, s[8:11], s36 offen sc1
  s_add_u32 s36, s36, 18432
  buffer_load_dwordx4 v[32:35], v6, s[8:11], s36 offen sc1
  s_add_u32 s36, s36, 18432
  buffer_load_dwordx4 v[36:39], v6, s[8:11], s36 offen sc1
  s_add_u32 s36, s36, 18432
  buffer_load_dwordx4 v[40:43], v6, s[8:11], s36 offen sc1
  s_add_u32 s36, s36, 18432
  buffer_load_dwordx4 v[44:47], v6, s[8:11], s36 offen sc1
  s_add_u32 s36, s36, 18432
  buffer_load_dwordx4 v[48:51], v6, s[8:11], s36 offen sc1
  s_add_u32 s36, s36, 18432
  buffer_load_dwordx4 v[52:55], v6, s[8:11], s36 offen sc1
  s_add_u32 s36, s36, 18432
  buffer_load_dwordx4 v[56:59], v6, s[8:11], s36 offen sc1
  s_add_u32 s36, s36, 18432
  buffer_load_dwordx4 v[60:63], v6, s[8:11], s36 offen sc1
  s_add_u32 s36, s36, 18432
  buffer_load_dwordx4 v[64:67], v6, s[8:11], s36 offen sc1
  s_add_u32 s36, s36, 18432
  buffer_load_dwordx4 v[68:71], v6, s[8:11], s36 offen sc1
  s_add_u32 s36, s36, 18432
  buffer_load_dwordx4 v[72:75], v6, s[8:11], s36 offen sc1
  s_add_u32 s36, s36, 18432
  buffer_load_dwordx4 v[76:79], v6, s[8:11], s36 offen sc1
  s_add_u32 s37, s37, 155648
  v_add_u32 v5, s37, v2
  s_waitcnt vmcnt(0)
  v_add_f32 v76, v76, v8
  v_add_f32 v77, v77, v9
  v_add_f32 v78, v78, v10
  v_add_f32 v79, v79, v11
  v_add_f32 v76, v76, v12
  v_add_f32 v77, v77, v13
  v_add_f32 v78, v78, v14
  v_add_f32 v79, v79, v15
  v_add_f32 v76, v76, v16
  v_add_f32 v77, v77, v17
  v_add_f32 v78, v78, v18
  v_add_f32 v79, v79, v19
  v_add_f32 v76, v76, v20
  v_add_f32 v77, v77, v21
  v_add_f32 v78, v78, v22
  v_add_f32 v79, v79, v23
  v_add_f32 v76, v76, v24
  v_add_f32 v77, v77, v25
  v_add_f32 v78, v78, v26
  v_add_f32 v79, v79, v27
  v_add_f32 v76, v76, v28
  v_add_f32 v77, v77, v29
  v_add_f32 v78, v78, v30
  v_add_f32 v79, v79, v31
  v_add_f32 v76, v76, v32
  v_add_f32 v77, v77, v33
  v_add_f32 v78, v78, v34
  v_add_f32 v79, v79, v35
  v_add_f32 v76, v76, v36
  v_add_f32 v77, v77, v37
  v_add_f32 v78, v78, v38
  v_add_f32 v79, v79, v39
  v_add_f32 v76, v76, v40
  v_add_f32 v77, v77, v41
  v_add_f32 v78, v78, v42
  v_add_f32 v79, v79, v43
  v_add_f32 v76, v76, v44
  v_add_f32 v77, v77, v45
  v_add_f32 v78, v78, v46
  v_add_f32 v79, v79, v47
  v_add_f32 v76, v76, v48
  v_add_f32 v77, v77, v49
  v_add_f32 v78, v78, v50
  v_add_f32 v79, v79, v51
  v_add_f32 v76, v76, v52
  v_add_f32 v77, v77, v53
  v_add_f32 v78, v78, v54
  v_add_f32 v79, v79, v55
  v_add_f32 v76, v76, v56
  v_add_f32 v77, v77, v57
  v_add_f32 v78, v78, v58
  v_add_f32 v79, v79, v59
  v_add_f32 v76, v76, v60
  v_add_f32 v77, v77, v61
  v_add_f32 v78, v78, v62
  v_add_f32 v79, v79, v63
  v_add_f32 v76, v76, v64
  v_add_f32 v77, v77, v65
  v_add_f32 v78, v78, v66
  v_add_f32 v79, v79, v67
  v_add_f32 v76, v76, v68
  v_add_f32 v77, v77, v69
  v_add_f32 v78, v78, v70
  v_add_f32 v79, v79, v71
  v_add_f32 v76, v76, v72
  v_add_f32 v77, v77, v73
  v_add_f32 v78, v78, v74
  v_add_f32 v79, v79, v75
  ds_write_b128 v5, v[76:79]
  s_waitcnt lgkmcnt(0)
  s_branch L_A_end
L_A_b1:
  s_mul_i32 s38, s32, 1152
  s_mov_b32 m0, 158720
  s_nop 0
  buffer_load_dwordx4 v2, s[12:15], s38 offen lds
  buffer_load_dwordx4 v2, s[12:15], s38 offen offset:1024 lds
  s_waitcnt vmcnt(0)
L_A_end:
  s_mul_i32 s39, s29, 73728
  s_cmp_ge_u32 s3, 5
  s_cselect_b32 s45, 1, 0
  s_mul_i32 s46, s45, 5
  s_sub_u32 s46, s3, s46
  v_lshrrev_b32 v7, 1, v3
  v_lshlrev_b32 v7, 10, v7
  v_and_b32 v6, 31, v1
  v_lshl_add_u32 v7, v6, 4, v7
  s_mul_i32 s40, s30, 9216
  s_add_u32 s40, s40, s39
  s_lshl_b32 s41, s46, 11
  s_add_u32 s40, s40, s41
  s_lshl_b32 s41, s45, 9
  s_add_u32 s40, s40, s41
  s_cmp_eq_u32 s46, 4
  s_cselect_b32 s41, 2, 4
  s_cmp_gt_u32 s46, 4
  s_cselect_b32 s41, 0, s41
  v_cmp_gt_u32 vcc, s41, v3
  v_mov_b32 v6, 0x70000000
  s_add_u32 s41, s40, s23
  v_cndmask_b32 v7, v6, v7, vcc
  buffer_load_dwordx4 v[72:75], v7, s[8:11], s41 offen sc1
  s_cmp_lg_u32 s3, 0
  s_cbranch_scc1 L_af_28
  s_add_u32 s36, s27, 4
  v_mov_b32 v8, s36
L_lw_29:
  ds_read_b32 v9, v8
  s_waitcnt lgkmcnt(0)
  v_readfirstlane_b32 s36, v9
  s_nop 3
  s_cmp_ge_u32 s36, 8
  s_cbranch_scc1 L_lw_29_ok
  s_sleep 1
  s_branch L_lw_29
L_lw_29_ok:
  s_lshl_b32 s37, s29, 10
  s_add_u32 s37, s37, s28
  s_add_u32 s37, s37, 0
  v_lshlrev_b32 v8, 7, v1
  s_mov_b32 exec_lo, 0xff
  s_mov_b32 exec_hi, 0x0
  s_mov_b32 s38, 0x20000
L_aw_30:
  v_mov_b32 v10, 0
  v_mov_b32 v11, 0
  buffer_atomic_or_x2 v[10:11], v8, s[8:11], s37 offen sc0 sc1
  s_waitcnt vmcnt(0)
  v_cmp_ne_u64 vcc, s[62:63], v[10:11]
  s_sub_u32 s38, s38, 1
  s_nop 3
  s_cbranch_vccz L_aw_30_ok
  s_cmp_eq_u32 s38, 0
  s_cbranch_scc1 L_aw_30_ok
  s_sleep 3
  s_branch L_aw_30
L_aw_30_ok:
  s_mov_b64 exec, -1
L_af_28:
  s_barrier
  s_mul_i32 s36, s3, 6144
  s_add_u32 s37, s39, s36
  s_add_u32 s37, s37, s24
  s_add_u32 m0, s36, 0
  s_nop 0
  buffer_load_dwordx4 v2, s[8:11], s37 offen offset:0 sc1 lds
  buffer_load_dwordx4 v2, s[8:11], s37 offen offset:1024 sc1 lds
  buffer_load_dwordx4 v2, s[8:11], s37 offen offset:2048 sc1 lds
  buffer_load_dwordx4 v2, s[8:11], s37 offen offset:3072 sc1 lds
  s_add_u32 m0, s36, 4096
  s_add_u32 s37, s37, 4096
  buffer_load_dwordx4 v2, s[8:11], s37 offen offset:0 sc1 lds
  buffer_load_dwordx4 v2, s[8:11], s37 offen offset:1024 sc1 lds
  v_lshlrev_b32 v5, 10, v3
  v_lshl_add_u32 v5, v4, 4, v5
  s_mul_i32 s41, s45, 36864
  v_add_u32 v5, s41, v5
  s_lshl_b32 s41, s45, 9
  s_xor_b32 s42, s41, 512
  v_add_u32 v6, s42, v5
  v_add_u32 v5, s41, v5
  s_waitcnt vmcnt(0)
  s_barrier
  s_cmp_ge_u32 s3, 10
  s_cbranch_scc1 L_B_idle
  ds_read_b128 v[24:27], v5 offset:0
  ds_read_b128 v[28:31], v5 offset:256
  ds_read_b128 v[32:35], v6 offset:0
  ds_read_b128 v[36:39], v6 offset:256
  ds_read_b128 v[40:43], v5 offset:4096
  ds_read_b128 v[44:47], v5 offset:4352
  ds_read_b128 v[48:51], v6 offset:4096
  ds_read_b128 v[52:55], v6 offset:4352
  ds_read_b128 v[56:59], v5 offset:8192
  ds_read_b128 v[60:63], v5 offset:8448
  ds_read_b128 v[64:67], v6 offset:8192
  ds_read_b128 v[68:71], v6 offset:8448
  s_waitcnt lgkmcnt(8)
  v_mfma_f32_16x16x32_bf16 v[16:19], v[124:127], v[32:35], 0
  v_mfma_f32_16x16x32_bf16 v[20:23], v[124:127], v[36:39], 0
  v_mfma_f32_16x16x32_bf16 v[8:11], v[124:127], v[24:27], 0
  v_mfma_f32_16x16x32_bf16 v[12:15], v[124:127], v[28:31], 0
  buffer_load_dwordx4 v[112:115], v2, s[8:11], s48 offen offset:0 sc1
  buffer_load_dwordx4 v[116:119], v2, s[8:11], s48 offen offset:1024 sc1
  buffer_load_dwordx4 v[120:123], v2, s[8:11], s48 offen offset:2048 sc1
  s_add_u32 s48, s48, 3072
  s_cmp_eq_u32 s48, s49
  s_cselect_b32 s48, s47, s48
  ds_read_b128 v[24:27], v5 offset:12288
  ds_read_b128 v[28:31], v5 offset:12544
  ds_read_b128 v[32:35], v6 offset:12288
  ds_read_b128 v[36:39], v6 offset:12544
  s_waitcnt lgkmcnt(8)
  v_mfma_f32_16x16x32_bf16 v[16:19], v[128:131], v[48:51], v[16:19]
  v_mfma_f32_16x16x32_bf16 v[20:23], v[128:131], v[52:55], v[20:23]
  v_mfma_f32_16x16x32_bf16 v[8:11], v[128:131], v[40:43], v[8:11]
  v_mfma_f32_16x16x32_bf16 v[12:15], v[128:131], v[44:47], v[12:15]
  ds_read_b128 v[40:43], v5 offset:16384
  ds_read_b128 v[44:47], v5 offset:16640
  ds_read_b128 v[48:51], v6 offset:16384
  ds_read_b128 v[52:55], v6 offset:16640
  s_waitcnt lgkmcnt(8)
  v_mfma_f32_16x16x32_bf16 v[16:19], v[132:135], v[64:67], v[16:19]
  v_mfma_f32_16x16x32_bf16 v[20:23], v[132:135], v[68:71], v[20:23]
  v_mfma_f32_16x16x32_bf16 v[8:11], v[132:135], v[56:59], v[8:11]
  v_mfma_f32_16x16x32_bf16 v[12:15], v[132:135], v[60:63], v[12:15]
  buffer_load_dwordx4 v[124:127], v2, s[8:11], s48 offen offset:0 sc1
  buffer_load_dwordx4 v[128:131], v2, s[8:11], s48 offen offset:1024 sc1
  buffer_load_dwordx4 v[132:135], v2, s[8:11], s48 offen offset:2048 sc1
  s_add_u32 s48, s48, 3072
  s_cmp_eq_u32 s48, s49
  s_cselect_b32 s48, s47, s48
  ds_read_b128 v[56:59], v5 offset:20480
  ds_read_b128 v[60:63], v5 offset:20736
  ds_read_b128 v[64:67], v6 offset:20480
  ds_read_b128 v[68:71], v6 offset:20736
  s_waitcnt lgkmcnt(8)
  v_mfma_f32_16x16x32_bf16 v[16:19], v[136:139], v[32:35], v[16:19]
  v_mfma_f32_16x16x32_bf16 v[20:23], v[136:139], v[36:39], v[20:23]
  v_mfma_f32_16x16x32_bf16 v[8:11], v[136:139], v[24:27], v[8:11]
  v_mfma_f32_16x16x32_bf16 v[12:15], v[136:139], v[28:31], v[12:15]
  ds_read_b128 v[24:27], v5 offset:24576
  ds_read_b128 v[28:31], v5 offset:24832
  ds_read_b128 v[32:35], v6 offset:24576
  ds_read_b128 v[36:39], v6 offset:24832
  s_waitcnt lgkmcnt(8)
  v_mfma_f32_16x16x32_bf16 v[16:19], v[140:143], v[48:51], v[16:19]
  v_mfma_f32_16x16x32_bf16 v[20:23], v[140:143], v[52:55], v[20:23]
  v_mfma_f32_16x16x32_bf16 v[8:11], v[140:143], v[40:43], v[8:11]
  v_mfma_f32_16x16x32_bf16 v[12:15], v[140:143], v[44:47], v[12:15]
  ds_read_b128 v[40:43], v5 offset:28672
  ds_read_b128 v[44:47], v5 offset:28928
  ds_read_b128 v[48:51], v6 offset:28672
  ds_read_b128 v[52:55], v6 offset:28928
  s_waitcnt lgkmcnt(8)
  v_mfma_f32_16x16x32_bf16 v[16:19], v[144:147], v[64:67], v[16:19]
  v_mfma_f32_16x16x32_bf16 v[20:23], v[144:147], v[68:71], v[20:23]
  v_mfma_f32_16x16x32_bf16 v[8:11], v[144:147], v[56:59], v[8:11]
  v_mfma_f32_16x16x32_bf16 v[12:15], v[144:147], v[60:63], v[12:15]
  buffer_load_dwordx4 v[136:139], v2, s[8:11], s48 offen offset:0 sc1
  buffer_load_dwordx4 v[140:143], v2, s[8:11], s48 offen offset:1024 sc1
  buffer_load_dwordx4 v[144:147], v2, s[8:11], s48 offen offset:2048 sc1
  s_add_u32 s48, s48, 3072
  s_cmp_eq_u32 s48, s49
  s_cselect_b32 s48, s47, s48
  ds_read_b128 v[56:59], v5 offset:32768
  ds_read_b128 v[60:63], v5 offset:33024
  ds_read_b128 v[64:67], v6 offset:32768
  ds_read_b128 v[68:71], v6 offset:33024
  s_waitcnt lgkmcnt(8)
  v_mfma_f32_16x16x32_bf16 v[16:19], v[148:151], v[32:35], v[16:19]
  v_mfma_f32_16x16x32_bf16 v[20:23], v[148:151], v[36:39], v[20:23]
  v_mfma_f32_16x16x32_bf16 v[8:11], v[148:151], v[24:27], v[8:11]
  v_mfma_f32_16x16x32_bf16 v[12:15], v[148:151], v[28:31], v[12:15]
  s_waitcnt lgkmcnt(4)
  v_mfma_f32_16x16x32_bf16 v[16:19], v[152:155], v[48:51], v[16:19]
  v_mfma_f32_16x16x32_bf16 v[20:23], v[152:155], v[52:55], v[20:23]
  v_mfma_f32_16x16x32_bf16 v[8:11], v[152:155], v[40:43], v[8:11]
  v_mfma_f32_16x16x32_bf16 v[12:15], v[152:155], v[44:47], v[12:15]
  s_waitcnt lgkmcnt(0)
  v_mfma_f32_16x16x32_bf16 v[16:19], v[156:159], v[64:67], v[16:19]
  v_mfma_f32_16x16x32_bf16 v[20:23], v[156:159], v[68:71], v[20:23]
  v_mfma_f32_16x16x32_bf16 v[8:11], v[156:159], v[56:59], v[8:11]
  v_mfma_f32_16x16x32_bf16 v[12:15], v[156:159], v[60:63], v[12:15]
  s_lshl_b32 s41, s3, 11
  s_add_u32 s41, s41, 73728
  v_add_u32 v5, s41, v2
  s_add_u32 s42, s3, 5
  s_sub_u32 s43, s3, 5
  s_cmp_ge_u32 s3, 5
  s_cselect_b32 s42, s43, s42
  s_lshl_b32 s42, s42, 11
  s_add_u32 s42, s42, 73728
  v_add_u32 v6, s42, v2
  s_nop 0
  ds_write_b128 v5, v[16:19]
  ds_write_b128 v5, v[20:23] offset:1024
  s_waitcnt lgkmcnt(0)
  s_barrier
  ds_read_b128 v[16:19], v6
  ds_read_b128 v[20:23], v6 offset:1024
  s_add_u32 s41, s40, s25
  s_waitcnt lgkmcnt(0)
  v_add_f32 v8, v8, v16
  v_add_f32 v9, v9, v17
  v_add_f32 v10, v10, v18
  v_add_f32 v11, v11, v19
  v_add_f32 v12, v12, v20
  v_add_f32 v13, v13, v21
  v_add_f32 v14, v14, v22
  v_add_f32 v15, v15, v23
  s_nop 1
  v_permlane16_swap_b32 v8, v12
  v_permlane16_swap_b32 v9, v13
  v_permlane16_swap_b32 v10, v14
  v_permlane16_swap_b32 v11, v15
  s_nop 1
  v_lshlrev_b32 v24, 16, v72
  v_and_b32 v25, 0xffff0000, v72
  v_add_f32 v8, v8, v24
  v_add_f32 v9, v9, v25
  v_cvt_pk_bf16_f32 v72, v8, v9
  v_lshlrev_b32 v24, 16, v73
  v_and_b32 v25, 0xffff0000, v73
  v_add_f32 v10, v10, v24
  v_add_f32 v11, v11, v25
  v_cvt_pk_bf16_f32 v73, v10, v11
  v_lshlrev_b32 v24, 16, v74
  v_and_b32 v25, 0xffff0000, v74
  v_add_f32 v12, v12, v24
  v_add_f32 v13, v13, v25
  v_cvt_pk_bf16_f32 v74, v12, v13
  v_lshlrev_b32 v24, 16, v75
  v_and_b32 v25, 0xffff0000, v75
  v_add_f32 v14, v14, v24
  v_add_f32 v15, v15, v25
  v_cvt_pk_bf16_f32 v75, v14, v15
  buffer_store_dwordx4 v[72:75], v7, s[8:11], s41 offen sc1
  s_add_u32 s36, s27, 8
  s_lshl_b32 s37, s29, 10
  s_lshl_b32 s38, s30, 7
  s_add_u32 s37, s37, s38
  s_add_u32 s37, s37, s28
  s_add_u32 s37, s37, 32768
  s_waitcnt vmcnt(0)
  v_mov_b32 v24, s36
  v_mov_b32 v25, 1
  s_mov_b64 exec, 1
  ds_add_rtn_u32 v24, v24, v25
  s_waitcnt lgkmcnt(0)
  v_readfirstlane_b32 s36, v24
  v_mov_b32 v24, s62
  v_mov_b32 v25, s63
  v_lshlrev_b32 v26, 13, v1
  s_nop 0
  s_cmp_lg_u32 s36, 9
  s_cbranch_scc1 L_pub_31
  buffer_store_dwordx2 v[24:25], v26, s[8:11], s37 offen sc1
L_pub_31:
  s_mov_b64 exec, -1
  s_branch L_B_end
L_B_idle:
  buffer_load_dwordx4 v[112:115], v2, s[8:11], s48 offen offset:0 sc1
  buffer_load_dwordx4 v[116:119], v2, s[8:11], s48 offen offset:1024 sc1
  buffer_load_dwordx4 v[120:123], v2, s[8:11], s48 offen offset:2048 sc1
  s_add_u32 s48, s48, 3072
  s_cmp_eq_u32 s48, s49
  s_cselect_b32 s48, s47, s48
  buffer_load_dwordx4 v[124:127], v2, s[8:11], s48 offen offset:0 sc1
  buffer_load_dwordx4 v[128:131], v2, s[8:11], s48 offen offset:1024 sc1
  buffer_load_dwordx4 v[132:135], v2, s[8:11], s48 offen offset:2048 sc1
  s_add_u32 s48, s48, 3072
  s_cmp_eq_u32 s48, s49
  s_cselect_b32 s48, s47, s48
  buffer_load_dwordx4 v[136:139], v2, s[8:11], s48 offen offset:0 sc1
  buffer_load_dwordx4 v[140:143], v2, s[8:11], s48 offen offset:1024 sc1
  buffer_load_dwordx4 v[144:147], v2, s[8:11], s48 offen offset:2048 sc1
  s_add_u32 s48, s48, 3072
  s_cmp_eq_u32 s48, s49
  s_cselect_b32 s48, s47, s48
  s_barrier
L_B_end:
  buffer_load_dwordx4 v[148:151], v2, s[8:11], s48 offen offset:0 sc1
  buffer_load_dwordx4 v[152:155], v2, s[8:11], s48 offen offset:1024 sc1
  buffer_load_dwordx4 v[156:159], v2, s[8:11], s48 offen offset:2048 sc1
  s_add_u32 s48, s48, 3072
  s_cmp_eq_u32 s48, s49
  s_cselect_b32 s48, s47, s48
  s_mul_i32 s39, s31, 73728
  s_cmp_lg_u32 s3, 0
  s_cbranch_scc1 L_af_32
  s_add_u32 s36, s27, 8
  v_mov_b32 v8, s36
L_lw_33:
  ds_read_b32 v9, v8
  s_waitcnt lgkmcnt(0)
  v_readfirstlane_b32 s36, v9
  s_nop 3
  s_cmp_ge_u32 s36, 10
  s_cbranch_scc1 L_lw_33_ok
  s_sleep 1
  s_branch L_lw_33
L_lw_33_ok:
  s_lshl_b32 s37, s31, 10
  s_add_u32 s37, s37, s28
  s_add_u32 s37, s37, 32768
  v_lshlrev_b32 v8, 7, v1
  s_mov_b32 exec_lo, 0xff
  s_mov_b32 exec_hi, 0x0
  s_mov_b32 s38, 0x20000
L_aw_34:
  v_mov_b32 v10, 0
  v_mov_b32 v11, 0
  buffer_atomic_or_x2 v[10:11], v8, s[8:11], s37 offen sc0 sc1
  s_waitcnt vmcnt(0)
  v_cmp_ne_u64 vcc, s[62:63], v[10:11]
  s_sub_u32 s38, s38, 1
  s_nop 3
  s_cbranch_vccz L_aw_34_ok
  s_cmp_eq_u32 s38, 0
  s_cbranch_scc1 L_aw_34_ok
  s_sleep 3
  s_branch L_aw_34
L_aw_34_ok:
  s_mov_b64 exec, -1
L_af_32:
  s_barrier
  s_mul_i32 s36, s3, 6144
  s_add_u32 s37, s36, s39
  s_add_u32 s37, s37, s25
  buffer_load_dwordx4 v[8:11], v2, s[8:11], s37 offen offset:0 sc1
  buffer_load_dwordx4 v[12:15], v2, s[8:11], s37 offen offset:1024 sc1
  buffer_load_dwordx4 v[16:19], v2, s[8:11], s37 offen offset:2048 sc1
  buffer_load_dwordx4 v[20:23], v2, s[8:11], s37 offen offset:3072 sc1
  s_add_u32 s37, s37, 4096
  buffer_load_dwordx4 v[24:27], v2, s[8:11], s37 offen offset:0 sc1
  buffer_load_dwordx4 v[28:31], v2, s[8:11], s37 offen offset:1024 sc1
  s_lshl_b32 s37, s34, 12
  s_sub_u32 s36, s36, s37
  s_add_u32 s36, s36, 73728
  s_mov_b32 s38, 0x3f803f80
  s_sub_u32 s37, s36, 73728
  s_cmp_ge_u32 s36, 73728
  s_cselect_b32 s36, s37, s36
  v_add_u32 v6, s36, v2
  s_waitcnt vmcnt(5)
  ds_write_b128 v6, v[8:11]
  v_dot2_f32_bf16 v44, v8, s38, 0
  v_dot2_f32_bf16 v45, v8, v8, 0
  v_dot2_f32_bf16 v44, v9, s38, v44
  v_dot2_f32_bf16 v45, v9, v9, v45
  v_dot2_f32_bf16 v44, v10, s38, v44
  v_dot2_f32_bf16 v45, v10, v10, v45
  v_dot2_f32_bf16 v44, v11, s38, v44
  v_dot2_f32_bf16 v45, v11, v11, v45
  s_add_u32 s36, s36, 1024
  s_sub_u32 s37, s36, 73728
  s_cmp_ge_u32 s36, 73728
  s_cselect_b32 s36, s37, s36
  v_add_u32 v6, s36, v2
  s_waitcnt vmcnt(4)
  ds_write_b128 v6, v[12:15]
  v_dot2_f32_bf16 v44, v12, s38, v44
  v_dot2_f32_bf16 v45, v12, v12, v45
  v_dot2_f32_bf16 v44, v13, s38, v44
  v_dot2_f32_bf16 v45, v13, v13, v45
  v_dot2_f32_bf16 v44, v14, s38, v44
  v_dot2_f32_bf16 v45, v14, v14, v45
  v_dot2_f32_bf16 v44, v15, s38, v44
  v_dot2_f32_bf16 v45, v15, v15, v45
  s_add_u32 s36, s36, 1024
  s_sub_u32 s37, s36, 73728
  s_cmp_ge_u32 s36, 73728
  s_cselect_b32 s36, s37, s36
  v_add_u32 v6, s36, v2
  s_waitcnt vmcnt(3)
  ds_write_b128 v6, v[16:19]
  v_dot2_f32_bf16 v44, v16, s38, v44
  v_dot2_f32_bf16 v45, v16, v16, v45
  v_dot2_f32_bf16 v44, v17, s38, v44
  v_dot2_f32_bf16 v45, v17, v17, v45
  v_dot2_f32_bf16 v44, v18, s38, v44
  v_dot2_f32_bf16 v45, v18, v18, v45
  v_dot2_f32_bf16 v44, v19, s38, v44
  v_dot2_f32_bf16 v45, v19, v19, v45
  s_add_u32 s36, s36, 1024
  s_sub_u32 s37, s36, 73728
  s_cmp_ge_u32 s36, 73728
  s_cselect_b32 s36, s37, s36
  v_add_u32 v6, s36, v2
  s_waitcnt vmcnt(2)
  ds_write_b128 v6, v[20:23]
  v_dot2_f32_bf16 v44, v20, s38, v44
  v_dot2_f32_bf16 v45, v20, v20, v45
  v_dot2_f32_bf16 v44, v21, s38, v44
  v_dot2_f32_bf16 v45, v21, v21, v45
  v_dot2_f32_bf16 v44, v22, s38, v44
  v_dot2_f32_bf16 v45, v22, v22, v45
  v_dot2_f32_bf16 v44, v23, s38, v44
  v_dot2_f32_bf16 v45, v23, v23, v45
  s_add_u32 s36, s36, 1024
  s_sub_u32 s37, s36, 73728
  s_cmp_ge_u32 s36, 73728
  s_cselect_b32 s36, s37, s36
  v_add_u32 v6, s36, v2
  s_waitcnt vmcnt(1)
  ds_write_b128 v6, v[24:27]
  v_dot2_f32_bf16 v44, v24, s38, v44
  v_dot2_f32_bf16 v45, v24, v24, v45
  v_dot2_f32_bf16 v44, v25, s38, v44
  v_dot2_f32_bf16 v45, v25, v25, v45
  v_dot2_f32_bf16 v44, v26, s38, v44
  v_dot2_f32_bf16 v45, v26, v26, v45
  v_dot2_f32_bf16 v44, v27, s38, v44
  v_dot2_f32_bf16 v45, v27, v27, v45
  s_add_u32 s36, s36, 1024
  s_sub_u32 s37, s36, 73728
  s_cmp_ge_u32 s36, 73728
  s_cselect_b32 s36, s37, s36
  v_add_u32 v6, s36, v2
  s_waitcnt vmcnt(0)
  ds_write_b128 v6, v[28:31]
  v_dot2_f32_bf16 v44, v28, s38, v44
  v_dot2_f32_bf16 v45, v28, v28, v45
  v_dot2_f32_bf16 v44, v29, s38, v44
  v_dot2_f32_bf16 v45, v29, v29, v45
  v_dot2_f32_bf16 v44, v30, s38, v44
  v_dot2_f32_bf16 v45, v30, v30, v45
  v_dot2_f32_bf16 v44, v31, s38, v44
  v_dot2_f32_bf16 v45, v31, v31, v45
  s_add_u32 s36, s36, 1024
  s_lshl_b32 s37, s3, 9
  v_lshlrev_b32 v6, 3, v1
  v_add_u32 v6, s37, v6
  v_add_u32 v6, 98304, v6
  ds_write_b64 v6, v[44:45]
L_C_s4:
  v_lshlrev_b32 v5, 10, v3
  v_lshl_add_u32 v5, v4, 4, v5
  s_waitcnt lgkmcnt(0)
  s_add_u32 s36, s27, 112
  s_lshl_b32 s37, s60, 2
  s_add_u32 s36, s36, s37
  v_mov_b32 v46, s36
  v_mov_b32 v47, 1
  s_mov_b64 exec, 1
  ds_add_u32 v46, v47
  s_mov_b64 exec, -1
  s_waitcnt lgkmcnt(0)
  s_cmp_lg_u32 s3, 11
  s_cbranch_scc1 L_C_nocomb
  s_add_u32 s36, s27, 112
  v_mov_b32 v8, s36
L_lw_35:
  ds_read_b32 v9, v8
  s_waitcnt lgkmcnt(0)
  v_readfirstlane_b32 s36, v9
  s_nop 3
  s_cmp_ge_u32 s36, 4
  s_cbranch_scc1 L_lw_35_ok
  s_sleep 2
  s_branch L_lw_35
L_lw_35_ok:
  s_add_u32 s36, s27, 116
  v_mov_b32 v8, s36
L_lw_36:
  ds_read_b32 v9, v8
  s_waitcnt lgkmcnt(0)
  v_readfirstlane_b32 s36, v9
  s_nop 3
  s_cmp_ge_u32 s36, 4
  s_cbranch_scc1 L_lw_36_ok
  s_sleep 2
  s_branch L_lw_36
L_lw_36_ok:
  s_add_u32 s36, s27, 120
  v_mov_b32 v8, s36
L_lw_37:
  ds_read_b32 v9, v8
  s_waitcnt lgkmcnt(0)
  v_readfirstlane_b32 s36, v9
  s_nop 3
  s_cmp_ge_u32 s36, 4
  s_cbranch_scc1 L_lw_37_ok
  s_sleep 2
  s_branch L_lw_37
L_lw_37_ok:
  v_lshlrev_b32 v6, 3, v1
  v_add_u32 v7, 98304, v6
  ds_read_b64 v[8:9], v7 offset:0
  ds_read_b64 v[10:11], v7 offset:512
  ds_read_b64 v[12:13], v7 offset:1024
  ds_read_b64 v[14:15], v7 offset:1536
  ds_read_b64 v[16:17], v7 offset:2048
  ds_read_b64 v[18:19], v7 offset:2560
  ds_read_b64 v[20:21], v7 offset:3072
  ds_read_b64 v[22:23], v7 offset:3584
  ds_read_b64 v[24:25], v7 offset:4096
  ds_read_b64 v[26:27], v7 offset:4608
  ds_read_b64 v[28:29], v7 offset:5120
  ds_read_b64 v[30:31], v7 offset:5632
  s_waitcnt lgkmcnt(0)
  v_add_f32 v8, v8, v30
  v_add_f32 v9, v9, v31
  v_add_f32 v10, v10, v28
  v_add_f32 v11, v11, v29
  v_add_f32 v12, v12, v26
  v_add_f32 v13, v13, v27
  v_add_f32 v14, v14, v24
  v_add_f32 v15, v15, v25
  v_add_f32 v16, v16, v22
  v_add_f32 v17, v17, v23
  v_add_f32 v18, v18, v20
  v_add_f32 v19, v19, v21
  v_add_f32 v8, v8, v18
  v_add_f32 v9, v9, v19
  v_add_f32 v10, v10, v16
  v_add_f32 v11, v11, v17
  v_add_f32 v12, v12, v14
  v_add_f32 v13, v13, v15
  v_add_f32 v8, v8, v12
  v_add_f32 v9, v9, v13
  v_add_f32 v8, v8, v10
  v_add_f32 v9, v9, v11
  v_mul_f32 v8, 0x3ae38e39, v8
  v_mul_f32 v9, 0x3ae38e39, v9
  v_fma_f32 v9, -v8, v8, v9
  v_max_f32 v9, 0, v9
  v_add_f32 v9, 0x3727c5ac, v9
  v_rsq_f32 v10, v9
  v_add_u32 v6, 147456, v6
  v_mul_f32 v11, v8, v10
  v_sub_f32 v11, 0, v11
  ds_write_b64 v6, v[10:11]
  s_waitcnt lgkmcnt(0)
  s_add_u32 s36, s27, 12
  v_mov_b32 v8, s36
  v_mov_b32 v9, 1
  s_mov_b64 exec, 1
  ds_add_u32 v8, v9
  s_mov_b64 exec, -1
  s_waitcnt lgkmcnt(0)
L_C_nocomb:
  v_add_u32 v6, 49152, v5
  s_setprio 2
  s_add_u32 s36, s27, 112
  v_mov_b32 v160, s36
L_lw_38:
  ds_read_b32 v161, v160
  s_waitcnt lgkmcnt(0)
  v_readfirstlane_b32 s36, v161
  s_nop 3
  s_cmp_ge_u32 s36, 4
  s_cbranch_scc1 L_lw_38_ok
  s_sleep 2
  s_branch L_lw_38
L_lw_38_ok:
  ds_read_b128 v[56:59], v5 offset:0
  ds_read_b128 v[60:63], v5 offset:256
  ds_read_b128 v[64:67], v5 offset:512
  ds_read_b128 v[68:71], v5 offset:768
  ds_read_b128 v[72:75], v5 offset:4096
  ds_read_b128 v[76:79], v5 offset:4352
  ds_read_b128 v[80:83], v5 offset:4608
  ds_read_b128 v[84:87], v5 offset:4864
  s_waitcnt lgkmcnt(4)
  v_mfma_f32_16x16x32_bf16 v[8:11], v[88:91], v[56:59], 0
  v_mfma_f32_16x16x32_bf16 v[12:15], v[92:95], v[56:59], 0
  v_mfma_f32_16x16x32_bf16 v[16:19], v[96:99], v[56:59], 0
  v_mfma_f32_16x16x32_bf16 v[28:31], v[96:99], v[60:63], 0
  v_mfma_f32_16x16x32_bf16 v[24:27], v[92:95], v[60:63], 0
  v_mfma_f32_16x16x32_bf16 v[20:23], v[88:91], v[60:63], 0
  v_mfma_f32_16x16x32_bf16 v[32:35], v[88:91], v[64:67], 0
  v_mfma_f32_16x16x32_bf16 v[36:39], v[92:95], v[64:67], 0
  v_mfma_f32_16x16x32_bf16 v[40:43], v[96:99], v[64:67], 0
  v_mfma_f32_16x16x32_bf16 v[52:55], v[96:99], v[68:71], 0
  v_mfma_f32_16x16x32_bf16 v[48:51], v[92:95], v[68:71], 0
  v_mfma_f32_16x16x32_bf16 v[44:47], v[88:91], v[68:71], 0
  buffer_load_dwordx4 v[88:91], v2, s[8:11], s48 offen offset:0 sc1
  buffer_load_dwordx4 v[92:95], v2, s[8:11], s48 offen offset:1024 sc1
  buffer_load_dwordx4 v[96:99], v2, s[8:11], s48 offen offset:2048 sc1
  s_add_u32 s48, s48, 3072
  s_cmp_eq_u32 s48, s49
  s_cselect_b32 s48, s47, s48
  ds_read_b128 v[56:59], v5 offset:8192
  ds_read_b128 v[60:63], v5 offset:8448
  ds_read_b128 v[64:67], v5 offset:8704
  ds_read_b128 v[68:71], v5 offset:8960
  s_waitcnt lgkmcnt(4)
  v_mfma_f32_16x16x32_bf16 v[8:11], v[100:103], v[72:75], v[8:11]
  v_mfma_f32_16x16x32_bf16 v[12:15], v[104:107], v[72:75], v[12:15]
  v_mfma_f32_16x16x32_bf16 v[16:19], v[108:111], v[72:75], v[16:19]
  v_mfma_f32_16x16x32_bf16 v[28:31], v[108:111], v[76:79], v[28:31]
  v_mfma_f32_16x16x32_bf16 v[24:27], v[104:107], v[76:79], v[24:27]
  v_mfma_f32_16x16x32_bf16 v[20:23], v[100:103], v[76:79], v[20:23]
  v_mfma_f32_16x16x32_bf16 v[32:35], v[100:103], v[80:83], v[32:35]
  v_mfma_f32_16x16x32_bf16 v[36:39], v[104:107], v[80:83], v[36:39]
  v_mfma_f32_16x16x32_bf16 v[40:43], v[108:111], v[80:83], v[40:43]
  v_mfma_f32_16x16x32_bf16 v[52:55], v[108:111], v[84:87], v[52:55]
  v_mfma_f32_16x16x32_bf16 v[48:51], v[104:107], v[84:87], v[48:51]
  v_mfma_f32_16x16x32_bf16 v[44:47], v[100:103], v[84:87], v[44:47]
  buffer_load_dwordx4 v[100:103], v2, s[8:11], s48 offen offset:0 sc1
  buffer_load_dwordx4 v[104:107], v2, s[8:11], s48 offen offset:1024 sc1
  buffer_load_dwordx4 v[108:111], v2, s[8:11], s48 offen offset:2048 sc1
  s_add_u32 s48, s48, 3072
  s_cmp_eq_u32 s48, s49
  s_cselect_b32 s48, s47, s48
  ds_read_b128 v[72:75], v5 offset:12288
  ds_read_b128 v[76:79], v5 offset:12544
  ds_read_b128 v[80:83], v5 offset:12800
  ds_read_b128 v[84:87], v5 offset:13056
  s_waitcnt lgkmcnt(4)
  v_mfma_f32_16x16x32_bf16 v[8:11], v[112:115], v[56:59], v[8:11]
  v_mfma_f32_16x16x32_bf16 v[12:15], v[116:119], v[56:59], v[12:15]
  v_mfma_f32_16x16x32_bf16 v[16:19], v[120:123], v[56:59], v[16:19]
  v_mfma_f32_16x16x32_bf16 v[28:31], v[120:123], v[60:63], v[28:31]
  v_mfma_f32_16x16x32_bf16 v[24:27], v[116:119], v[60:63], v[24:27]
  v_mfma_f32_16x16x32_bf16 v[20:23], v[112:115], v[60:63], v[20:23]
  v_mfma_f32_16x16x32_bf16 v[32:35], v[112:115], v[64:67], v[32:35]
  v_mfma_f32_16x16x32_bf16 v[36:39], v[116:119], v[64:67], v[36:39]
  v_mfma_f32_16x16x32_bf16 v[40:43], v[120:123], v[64:67], v[40:43]
  v_mfma_f32_16x16x32_bf16 v[52:55], v[120:123], v[68:71], v[52:55]
  v_mfma_f32_16x16x32_bf16 v[48:51], v[116:119], v[68:71], v[48:51]
  v_mfma_f32_16x16x32_bf16 v[44:47], v[112:115], v[68:71], v[44:47]
  buffer_load_dwordx4 v[112:115], v2, s[8:11], s48 offen offset:0 sc1
  buffer_load_dwordx4 v[116:119], v2, s[8:11], s48 offen offset:1024 sc1
  buffer_load_dwordx4 v[120:123], v2, s[8:11], s48 offen offset:2048 sc1
  s_add_u32 s48, s48, 3072
  s_cmp_eq_u32 s48, s49
  s_cselect_b32 s48, s47, s48
  ds_read_b128 v[56:59], v5 offset:16384
  ds_read_b128 v[60:63], v5 offset:16640
  ds_read_b128 v[64:67], v5 offset:16896
  ds_read_b128 v[68:71], v5 offset:17152
  s_waitcnt lgkmcnt(4)
  v_mfma_f32_16x16x32_bf16 v[8:11], v[124:127], v[72:75], v[8:11]
  v_mfma_f32_16x16x32_bf16 v[12:15], v[128:131], v[72:75], v[12:15]
  v_mfma_f32_16x16x32_bf16 v[16:19], v[132:135], v[72:75], v[16:19]
  v_mfma_f32_16x16x32_bf16 v[28:31], v[132:135], v[76:79], v[28:31]
  v_mfma_f32_16x16x32_bf16 v[24:27], v[128:131], v[76:79], v[24:27]
  v_mfma_f32_16x16x32_bf16 v[20:23], v[124:127], v[76:79], v[20:23]
  v_mfma_f32_16x16x32_bf16 v[32:35], v[124:127], v[80:83], v[32:35]
  v_mfma_f32_16x16x32_bf16 v[36:39], v[128:131], v[80:83], v[36:39]
  v_mfma_f32_16x16x32_bf16 v[40:43], v[132:135], v[80:83], v[40:43]
  v_mfma_f32_16x16x32_bf16 v[52:55], v[132:135], v[84:87], v[52:55]
  v_mfma_f32_16x16x32_bf16 v[48:51], v[128:131], v[84:87], v[48:51]
  v_mfma_f32_16x16x32_bf16 v[44:47], v[124:127], v[84:87], v[44:47]
  buffer_load_dwordx4 v[124:127], v2, s[8:11], s48 offen offset:0 sc1
  buffer_load_dwordx4 v[128:131], v2, s[8:11], s48 offen offset:1024 sc1
  buffer_load_dwordx4 v[132:135], v2, s[8:11], s48 offen offset:2048 sc1
  s_add_u32 s48, s48, 3072
  s_cmp_eq_u32 s48, s49
  s_cselect_b32 s48, s47, s48
  ds_read_b128 v[72:75], v5 offset:20480
  ds_read_b128 v[76:79], v5 offset:20736
  ds_read_b128 v[80:83], v5 offset:20992
  ds_read_b128 v[84:87], v5 offset:21248
  s_waitcnt lgkmcnt(4)
  v_mfma_f32_16x16x32_bf16 v[8:11], v[136:139], v[56:59], v[8:11]
  v_mfma_f32_16x16x32_bf16 v[12:15], v[140:143], v[56:59], v[12:15]
  v_mfma_f32_16x16x32_bf16 v[16:19], v[144:147], v[56:59], v[16:19]
  v_mfma_f32_16x16x32_bf16 v[28:31], v[144:147], v[60:63], v[28:31]
  v_mfma_f32_16x16x32_bf16 v[24:27], v[140:143], v[60:63], v[24:27]
  v_mfma_f32_16x16x32_bf16 v[20:23], v[136:139], v[60:63], v[20:23]
  v_mfma_f32_16x16x32_bf16 v[32:35], v[136:139], v[64:67], v[32:35]
  v_mfma_f32_16x16x32_bf16 v[36:39], v[140:143], v[64:67], v[36:39]
  v_mfma_f32_16x16x32_bf16 v[40:43], v[144:147], v[64:67], v[40:43]
  v_mfma_f32_16x16x32_bf16 v[52:55], v[144:147], v[68:71], v[52:55]
  v_mfma_f32_16x16x32_bf16 v[48:51], v[140:143], v[68:71], v[48:51]
  v_mfma_f32_16x16x32_bf16 v[44:47], v[136:139], v[68:71], v[44:47]
  buffer_load_dwordx4 v[136:139], v2, s[8:11], s48 offen offset:0 sc1
  buffer_load_dwordx4 v[140:143], v2, s[8:11], s48 offen offset:1024 sc1
  buffer_load_dwordx4 v[144:147], v2, s[8:11], s48 offen offset:2048 sc1
  s_add_u32 s48, s48, 3072
  s_cmp_eq_u32 s48, s49
  s_cselect_b32 s48, s47, s48
  s_waitcnt lgkmcnt(0)
  v_mfma_f32_16x16x32_bf16 v[8:11], v[148:151], v[72:75], v[8:11]
  v_mfma_f32_16x16x32_bf16 v[12:15], v[152:155], v[72:75], v[12:15]
  v_mfma_f32_16x16x32_bf16 v[16:19], v[156:159], v[72:75], v[16:19]
  v_mfma_f32_16x16x32_bf16 v[28:31], v[156:159], v[76:79], v[28:31]
  v_mfma_f32_16x16x32_bf16 v[24:27], v[152:155], v[76:79], v[24:27]
  v_mfma_f32_16x16x32_bf16 v[20:23], v[148:151], v[76:79], v[20:23]
  v_mfma_f32_16x16x32_bf16 v[32:35], v[148:151], v[80:83], v[32:35]
  v_mfma_f32_16x16x32_bf16 v[36:39], v[152:155], v[80:83], v[36:39]
  v_mfma_f32_16x16x32_bf16 v[40:43], v[156:159], v[80:83], v[40:43]
  v_mfma_f32_16x16x32_bf16 v[52:55], v[156:159], v[84:87], v[52:55]
  v_mfma_f32_16x16x32_bf16 v[48:51], v[152:155], v[84:87], v[48:51]
  v_mfma_f32_16x16x32_bf16 v[44:47], v[148:151], v[84:87], v[44:47]
  buffer_load_dwordx4 v[148:151], v2, s[8:11], s48 offen offset:0 sc1
  buffer_load_dwordx4 v[152:155], v2, s[8:11], s48 offen offset:1024 sc1
  buffer_load_dwordx4 v[156:159], v2, s[8:11], s48 offen offset:2048 sc1
  s_add_u32 s48, s48, 3072
  s_cmp_eq_u32 s48, s49
  s_cselect_b32 s48, s47, s48
  s_add_u32 s36, s27, 116
  v_mov_b32 v160, s36
L_lw_39:
  ds_read_b32 v161, v160
  s_waitcnt lgkmcnt(0)
  v_readfirstlane_b32 s36, v161
  s_nop 3
  s_cmp_ge_u32 s36, 4
  s_cbranch_scc1 L_lw_39_ok
  s_sleep 2
  s_branch L_lw_39
L_lw_39_ok:
  ds_read_b128 v[56:59], v5 offset:24576
  ds_read_b128 v[60:63], v5 offset:24832
  ds_read_b128 v[64:67], v5 offset:25088
  ds_read_b128 v[68:71], v5 offset:25344
  ds_read_b128 v[72:75], v5 offset:28672
  ds_read_b128 v[76:79], v5 offset:28928
  ds_read_b128 v[80:83], v5 offset:29184
  ds_read_b128 v[84:87], v5 offset:29440
  s_waitcnt vmcnt(15) lgkmcnt(4)
  v_mfma_f32_16x16x32_bf16 v[8:11], v[88:91], v[56:59], v[8:11]
  v_mfma_f32_16x16x32_bf16 v[12:15], v[92:95], v[56:59], v[12:15]
  v_mfma_f32_16x16x32_bf16 v[16:19], v[96:99], v[56:59], v[16:19]
  v_mfma_f32_16x16x32_bf16 v[28:31], v[96:99], v[60:63], v[28:31]
  v_mfma_f32_16x16x32_bf16 v[24:27], v[92:95], v[60:63], v[24:27]
  v_mfma_f32_16x16x32_bf16 v[20:23], v[88:91], v[60:63], v[20:23]
  v_mfma_f32_16x16x32_bf16 v[32:35], v[88:91], v[64:67], v[32:35]
  v_mfma_f32_16x16x32_bf16 v[36:39], v[92:95], v[64:67], v[36:39]
  v_mfma_f32_16x16x32_bf16 v[40:43], v[96:99], v[64:67], v[40:43]
  v_mfma_f32_16x16x32_bf16 v[52:55], v[96:99], v[68:71], v[52:55]
  v_mfma_f32_16x16x32_bf16 v[48:51], v[92:95], v[68:71], v[48:51]
  v_mfma_f32_16x16x32_bf16 v[44:47], v[88:91], v[68:71], v[44:47]
  buffer_load_dwordx4 v[88:91], v2, s[8:11], s48 offen offset:0 sc1
  buffer_load_dwordx4 v[92:95], v2, s[8:11], s48 offen offset:1024 sc1
  buffer_load_dwordx4 v[96:99], v2, s[8:11], s48 offen offset:2048 sc1
  s_add_u32 s48, s48, 3072
  s_cmp_eq_u32 s48, s49
  s_cselect_b32 s48, s47, s48
  ds_read_b128 v[56:59], v5 offset:32768
  ds_read_b128 v[60:63], v5 offset:33024
  ds_read_b128 v[64:67], v5 offset:33280
  ds_read_b128 v[68:71], v5 offset:33536
  s_waitcnt vmcnt(15) lgkmcnt(4)
  v_mfma_f32_16x16x32_bf16 v[8:11], v[100:103], v[72:75], v[8:11]
  v_mfma_f32_16x16x32_bf16 v[12:15], v[104:107], v[72:75], v[12:15]
  v_mfma_f32_16x16x32_bf16 v[16:19], v[108:111], v[72:75], v[16:19]
  v_mfma_f32_16x16x32_bf16 v[28:31], v[108:111], v[76:79], v[28:31]
  v_mfma_f32_16x16x32_bf16 v[24:27], v[104:107], v[76:79], v[24:27]
  v_mfma_f32_16x16x32_bf16 v[20:23], v[100:103], v[76:79], v[20:23]
  v_mfma_f32_16x16x32_bf16 v[32:35], v[100:103], v[80:83], v[32:35]
  v_mfma_f32_16x16x32_bf16 v[36:39], v[104:107], v[80:83], v[36:39]
  v_mfma_f32_16x16x32_bf16 v[40:43], v[108:111], v[80:83], v[40:43]
  v_mfma_f32_16x16x32_bf16 v[52:55], v[108:111], v[84:87], v[52:55]
  v_mfma_f32_16x16x32_bf16 v[48:51], v[104:107], v[84:87], v[48:51]
  v_mfma_f32_16x16x32_bf16 v[44:47], v[100:103], v[84:87], v[44:47]
  buffer_load_dwordx4 v[100:103], v2, s[8:11], s48 offen offset:0 sc1
  buffer_load_dwordx4 v[104:107], v2, s[8:11], s48 offen offset:1024 sc1
  buffer_load_dwordx4 v[108:111], v2, s[8:11], s48 offen offset:2048 sc1
  s_add_u32 s48, s48, 3072
  s_cmp_eq_u32 s48, s49
  s_cselect_b32 s48, s47, s48
  ds_read_b128 v[72:75], v5 offset:36864
  ds_read_b128 v[76:79], v5 offset:37120
  ds_read_b128 v[80:83], v5 offset:37376
  ds_read_b128 v[84:87], v5 offset:37632
  s_waitcnt vmcnt(15) lgkmcnt(4)
  v_mfma_f32_16x16x32_bf16 v[8:11], v[112:115], v[56:59], v[8:11]
  v_mfma_f32_16x16x32_bf16 v[12:15], v[116:119], v[56:59], v[12:15]
  v_mfma_f32_16x16x32_bf16 v[16:19], v[120:123], v[56:59], v[16:19]
  v_mfma_f32_16x16x32_bf16 v[28:31], v[120:123], v[60:63], v[28:31]
  v_mfma_f32_16x16x32_bf16 v[24:27], v[116:119], v[60:63], v[24:27]
  v_mfma_f32_16x16x32_bf16 v[20:23], v[112:115], v[60:63], v[20:23]
  v_mfma_f32_16x16x32_bf16 v[32:35], v[112:115], v[64:67], v[32:35]
  v_mfma_f32_16x16x32_bf16 v[36:39], v[116:119], v[64:67], v[36:39]
  v_mfma_f32_16x16x32_bf16 v[40:43], v[120:123], v[64:67], v[40:43]
  v_mfma_f32_16x16x32_bf16 v[52:55], v[120:123], v[68:71], v[52:55]
  v_mfma_f32_16x16x32_bf16 v[48:51], v[116:119], v[68:71], v[48:51]
  v_mfma_f32_16x16x32_bf16 v[44:47], v[112:115], v[68:71], v[44:47]
  buffer_load_dwordx4 v[112:115], v2, s[8:11], s48 offen offset:0 sc1
  buffer_load_dwordx4 v[116:119], v2, s[8:11], s48 offen offset:1024 sc1
  buffer_load_dwordx4 v[120:123], v2, s[8:11], s48 offen offset:2048 sc1
  s_add_u32 s48, s48, 3072
  s_cmp_eq_u32 s48, s49
  s_cselect_b32 s48, s47, s48
  ds_read_b128 v[56:59], v5 offset:40960
  ds_read_b128 v[60:63], v5 offset:41216
  ds_read_b128 v[64:67], v5 offset:41472
  ds_read_b128 v[68:71], v5 offset:41728
  s_waitcnt vmcnt(15) lgkmcnt(4)
  v_mfma_f32_16x16x32_bf16 v[8:11], v[124:127], v[72:75], v[8:11]
  v_mfma_f32_16x16x32_bf16 v[12:15], v[128:131], v[72:75], v[12:15]
  v_mfma_f32_16x16x32_bf16 v[16:19], v[132:135], v[72:75], v[16:19]
  v_mfma_f32_16x16x32_bf16 v[28:31], v[132:135], v[76:79], v[28:31]
  v_mfma_f32_16x16x32_bf16 v[24:27], v[128:131], v[76:79], v[24:27]
  v_mfma_f32_16x16x32_bf16 v[20:23], v[124:127], v[76:79], v[20:23]
  v_mfma_f32_16x16x32_bf16 v[32:35], v[124:127], v[80:83], v[32:35]
  v_mfma_f32_16x16x32_bf16 v[36:39], v[128:131], v[80:83], v[36:39]
  v_mfma_f32_16x16x32_bf16 v[40:43], v[132:135], v[80:83], v[40:43]
  v_mfma_f32_16x16x32_bf16 v[52:55], v[132:135], v[84:87], v[52:55]
  v_mfma_f32_16x16x32_bf16 v[48:51], v[128:131], v[84:87], v[48:51]
  v_mfma_f32_16x16x32_bf16 v[44:47], v[124:127], v[84:87], v[44:47]
  buffer_load_dwordx4 v[124:127], v2, s[8:11], s48 offen offset:0 sc1
  buffer_load_dwordx4 v[128:131], v2, s[8:11], s48 offen offset:1024 sc1
  buffer_load_dwordx4 v[132:135], v2, s[8:11], s48 offen offset:2048 sc1
  s_add_u32 s48, s48, 3072
  s_cmp_eq_u32 s48, s49
  s_cselect_b32 s48, s47, s48
  ds_read_b128 v[72:75], v5 offset:45056
  ds_read_b128 v[76:79], v5 offset:45312
  ds_read_b128 v[80:83], v5 offset:45568
  ds_read_b128 v[84:87], v5 offset:45824
  s_waitcnt vmcnt(15) lgkmcnt(4)
  v_mfma_f32_16x16x32_bf16 v[8:11], v[136:139], v[56:59], v[8:11]
  v_mfma_f32_16x16x32_bf16 v[12:15], v[140:143], v[56:59], v[12:15]
  v_mfma_f32_16x16x32_bf16 v[16:19], v[144:147], v[56:59], v[16:19]
  v_mfma_f32_16x16x32_bf16 v[28:31], v[144:147], v[60:63], v[28:31]
  v_mfma_f32_16x16x32_bf16 v[24:27], v[140:143], v[60:63], v[24:27]
  v_mfma_f32_16x16x32_bf16 v[20:23], v[136:139], v[60:63], v[20:23]
  v_mfma_f32_16x16x32_bf16 v[32:35], v[136:139], v[64:67], v[32:35]
  v_mfma_f32_16x16x32_bf16 v[36:39], v[140:143], v[64:67], v[36:39]
  v_mfma_f32_16x16x32_bf16 v[40:43], v[144:147], v[64:67], v[40:43]
  v_mfma_f32_16x16x32_bf16 v[52:55], v[144:147], v[68:71], v[52:55]
  v_mfma_f32_16x16x32_bf16 v[48:51], v[140:143], v[68:71], v[48:51]
  v_mfma_f32_16x16x32_bf16 v[44:47], v[136:139], v[68:71], v[44:47]
  buffer_load_dwordx4 v[136:139], v2, s[8:11], s48 offen offset:0 sc1
  buffer_load_dwordx4 v[140:143], v2, s[8:11], s48 offen offset:1024 sc1
  buffer_load_dwordx4 v[144:147], v2, s[8:11], s48 offen offset:2048 sc1
  s_add_u32 s48, s48, 3072
  s_cmp_eq_u32 s48, s49
  s_cselect_b32 s48, s47, s48
  s_waitcnt vmcnt(15) lgkmcnt(0)
  v_mfma_f32_16x16x32_bf16 v[8:11], v[148:151], v[72:75], v[8:11]
  v_mfma_f32_16x16x32_bf16 v[12:15], v[152:155], v[72:75], v[12:15]
  v_mfma_f32_16x16x32_bf16 v[16:19], v[156:159], v[72:75], v[16:19]
  v_mfma_f32_16x16x32_bf16 v[28:31], v[156:159], v[76:79], v[28:31]
  v_mfma_f32_16x16x32_bf16 v[24:27], v[152:155], v[76:79], v[24:27]
  v_mfma_f32_16x16x32_bf16 v[20:23], v[148:151], v[76:79], v[20:23]
  v_mfma_f32_16x16x32_bf16 v[32:35], v[148:151], v[80:83], v[32:35]
  v_mfma_f32_16x16x32_bf16 v[36:39], v[152:155], v[80:83], v[36:39]
  v_mfma_f32_16x16x32_bf16 v[40:43], v[156:159], v[80:83], v[40:43]
  v_mfma_f32_16x16x32_bf16 v[52:55], v[156:159], v[84:87], v[52:55]
  v_mfma_f32_16x16x32_bf16 v[48:51], v[152:155], v[84:87], v[48:51]
  v_mfma_f32_16x16x32_bf16 v[44:47], v[148:151], v[84:87], v[44:47]
  buffer_load_dwordx4 v[148:151], v2, s[8:11], s48 offen offset:0 sc1
  buffer_load_dwordx4 v[152:155], v2, s[8:11], s48 offen offset:1024 sc1
  buffer_load_dwordx4 v[156:159], v2, s[8:11], s48 offen offset:2048 sc1
  s_add_u32 s48, s48, 3072
  s_cmp_eq_u32 s48, s49
  s_cselect_b32 s48, s47, s48
  s_add_u32 s36, s27, 120
  v_mov_b32 v160, s36
L_lw_40:
  ds_read_b32 v161, v160
  s_waitcnt lgkmcnt(0)
  v_readfirstlane_b32 s36, v161
  s_nop 3
  s_cmp_ge_u32 s36, 4
  s_cbranch_scc1 L_lw_40_ok
  s_sleep 2
  s_branch L_lw_40
L_lw_40_ok:
  ds_read_b128 v[56:59], v6 offset:0
  ds_read_b128 v[60:63], v6 offset:256
  ds_read_b128 v[64:67], v6 offset:512
  ds_read_b128 v[68:71], v6 offset:768
  ds_read_b128 v[72:75], v6 offset:4096
  ds_read_b128 v[76:79], v6 offset:4352
  ds_read_b128 v[80:83], v6 offset:4608
  ds_read_b128 v[84:87], v6 offset:4864
  s_waitcnt vmcnt(15) lgkmcnt(4)
  v_mfma_f32_16x16x32_bf16 v[8:11], v[88:91], v[56:59], v[8:11]
  v_mfma_f32_16x16x32_bf16 v[12:15], v[92:95], v[56:59], v[12:15]
  v_mfma_f32_16x16x32_bf16 v[16:19], v[96:99], v[56:59], v[16:19]
  v_mfma_f32_16x16x32_bf16 v[28:31], v[96:99], v[60:63], v[28:31]
  v_mfma_f32_16x16x32_bf16 v[24:27], v[92:95], v[60:63], v[24:27]
  v_mfma_f32_16x16x32_bf16 v[20:23], v[88:91], v[60:63], v[20:23]
  v_mfma_f32_16x16x32_bf16 v[32:35], v[88:91], v[64:67], v[32:35]
  v_mfma_f32_16x16x32_bf16 v[36:39], v[92:95], v[64:67], v[36:39]
  v_mfma_f32_16x16x32_bf16 v[40:43], v[96:99], v[64:67], v[40:43]
  v_mfma_f32_16x16x32_bf16 v[52:55], v[96:99], v[68:71], v[52:55]
  v_mfma_f32_16x16x32_bf16 v[48:51], v[92:95], v[68:71], v[48:51]
  v_mfma_f32_16x16x32_bf16 v[44:47], v[88:91], v[68:71], v[44:47]
  ds_read_b128 v[56:59], v6 offset:8192
  ds_read_b128 v[60:63], v6 offset:8448
  ds_read_b128 v[64:67], v6 offset:8704
  ds_read_b128 v[68:71], v6 offset:8960
  s_waitcnt vmcnt(12) lgkmcnt(4)
  v_mfma_f32_16x16x32_bf16 v[8:11], v[100:103], v[72:75], v[8:11]
  v_mfma_f32_16x16x32_bf16 v[12:15], v[104:107], v[72:75], v[12:15]
  v_mfma_f32_16x16x32_bf16 v[16:19], v[108:111], v[72:75], v[16:19]
  v_mfma_f32_16x16x32_bf16 v[28:31], v[108:111], v[76:79], v[28:31]
  v_mfma_f32_16x16x32_bf16 v[24:27], v[104:107], v[76:79], v[24:27]
  v_mfma_f32_16x16x32_bf16 v[20:23], v[100:103], v[76:79], v[20:23]
  v_mfma_f32_16x16x32_bf16 v[32:35], v[100:103], v[80:83], v[32:35]
  v_mfma_f32_16x16x32_bf16 v[36:39], v[104:107], v[80:83], v[36:39]
  v_mfma_f32_16x16x32_bf16 v[40:43], v[108:111], v[80:83], v[40:43]
  v_mfma_f32_16x16x32_bf16 v[52:55], v[108:111], v[84:87], v[52:55]
  v_mfma_f32_16x16x32_bf16 v[48:51], v[104:107], v[84:87], v[48:51]
  v_mfma_f32_16x16x32_bf16 v[44:47], v[100:103], v[84:87], v[44:47]
  ds_read_b128 v[72:75], v6 offset:12288
  ds_read_b128 v[76:79], v6 offset:12544
  ds_read_b128 v[80:83], v6 offset:12800
  ds_read_b128 v[84:87], v6 offset:13056
  s_waitcnt vmcnt(9) lgkmcnt(4)
  v_mfma_f32_16x16x32_bf16 v[8:11], v[112:115], v[56:59], v[8:11]
  v_mfma_f32_16x16x32_bf16 v[12:15], v[116:119], v[56:59], v[12:15]
  v_mfma_f32_16x16x32_bf16 v[16:19], v[120:123], v[56:59], v[16:19]
  v_mfma_f32_16x16x32_bf16 v[28:31], v[120:123], v[60:63], v[28:31]
  v_mfma_f32_16x16x32_bf16 v[24:27], v[116:119], v[60:63], v[24:27]
  v_mfma_f32_16x16x32_bf16 v[20:23], v[112:115], v[60:63], v[20:23]
  v_mfma_f32_16x16x32_bf16 v[32:35], v[112:115], v[64:67], v[32:35]
  v_mfma_f32_16x16x32_bf16 v[36:39], v[116:119], v[64:67], v[36:39]
  v_mfma_f32_16x16x32_bf16 v[40:43], v[120:123], v[64:67], v[40:43]
  v_mfma_f32_16x16x32_bf16 v[52:55], v[120:123], v[68:71], v[52:55]
  v_mfma_f32_16x16x32_bf16 v[48:51], v[116:119], v[68:71], v[48:51]
  v_mfma_f32_16x16x32_bf16 v[44:47], v[112:115], v[68:71], v[44:47]
  ds_read_b128 v[56:59], v6 offset:16384
  ds_read_b128 v[60:63], v6 offset:16640
  ds_read_b128 v[64:67], v6 offset:16896
  ds_read_b128 v[68:71], v6 offset:17152
  s_waitcnt vmcnt(6) lgkmcnt(4)
  v_mfma_f32_16x16x32_bf16 v[8:11], v[124:127], v[72:75], v[8:11]
  v_mfma_f32_16x16x32_bf16 v[12:15], v[128:131], v[72:75], v[12:15]
  v_mfma_f32_16x16x32_bf16 v[16:19], v[132:135], v[72:75], v[16:19]
  v_mfma_f32_16x16x32_bf16 v[28:31], v[132:135], v[76:79], v[28:31]
  v_mfma_f32_16x16x32_bf16 v[24:27], v[128:131], v[76:79], v[24:27]
  v_mfma_f32_16x16x32_bf16 v[20:23], v[124:127], v[76:79], v[20:23]
  v_mfma_f32_16x16x32_bf16 v[32:35], v[124:127], v[80:83], v[32:35]
  v_mfma_f32_16x16x32_bf16 v[36:39], v[128:131], v[80:83], v[36:39]
  v_mfma_f32_16x16x32_bf16 v[40:43], v[132:135], v[80:83], v[40:43]
  v_mfma_f32_16x16x32_bf16 v[52:55], v[132:135], v[84:87], v[52:55]
  v_mfma_f32_16x16x32_bf16 v[48:51], v[128:131], v[84:87], v[48:51]
  v_mfma_f32_16x16x32_bf16 v[44:47], v[124:127], v[84:87], v[44:47]
  ds_read_b128 v[72:75], v6 offset:20480
  ds_read_b128 v[76:79], v6 offset:20736
  ds_read_b128 v[80:83], v6 offset:20992
  ds_read_b128 v[84:87], v6 offset:21248
  s_waitcnt vmcnt(3) lgkmcnt(4)
  v_mfma_f32_16x16x32_bf16 v[8:11], v[136:139], v[56:59], v[8:11]
  v_mfma_f32_16x16x32_bf16 v[12:15], v[140:143], v[56:59], v[12:15]
  v_mfma_f32_16x16x32_bf16 v[16:19], v[144:147], v[56:59], v[16:19]
  v_mfma_f32_16x16x32_bf16 v[28:31], v[144:147], v[60:63], v[28:31]
  v_mfma_f32_16x16x32_bf16 v[24:27], v[140:143], v[60:63], v[24:27]
  v_mfma_f32_16x16x32_bf16 v[20:23], v[136:139], v[60:63], v[20:23]
  v_mfma_f32_16x16x32_bf16 v[32:35], v[136:139], v[64:67], v[32:35]
  v_mfma_f32_16x16x32_bf16 v[36:39], v[140:143], v[64:67], v[36:39]
  v_mfma_f32_16x16x32_bf16 v[40:43], v[144:147], v[64:67], v[40:43]
  v_mfma_f32_16x16x32_bf16 v[52:55], v[144:147], v[68:71], v[52:55]
  v_mfma_f32_16x16x32_bf16 v[48:51], v[140:143], v[68:71], v[48:51]
  v_mfma_f32_16x16x32_bf16 v[44:47], v[136:139], v[68:71], v[44:47]
  s_waitcnt vmcnt(0) lgkmcnt(0)
  v_mfma_f32_16x16x32_bf16 v[8:11], v[148:151], v[72:75], v[8:11]
  v_mfma_f32_16x16x32_bf16 v[12:15], v[152:155], v[72:75], v[12:15]
  v_mfma_f32_16x16x32_bf16 v[16:19], v[156:159], v[72:75], v[16:19]
  v_mfma_f32_16x16x32_bf16 v[28:31], v[156:159], v[76:79], v[28:31]
  v_mfma_f32_16x16x32_bf16 v[24:27], v[152:155], v[76:79], v[24:27]
  v_mfma_f32_16x16x32_bf16 v[20:23], v[148:151], v[76:79], v[20:23]
  v_mfma_f32_16x16x32_bf16 v[32:35], v[148:151], v[80:83], v[32:35]
  v_mfma_f32_16x16x32_bf16 v[36:39], v[152:155], v[80:83], v[36:39]
  v_mfma_f32_16x16x32_bf16 v[40:43], v[156:159], v[80:83], v[40:43]
  v_mfma_f32_16x16x32_bf16 v[52:55], v[156:159], v[84:87], v[52:55]
  v_mfma_f32_16x16x32_bf16 v[48:51], v[152:155], v[84:87], v[48:51]
  v_mfma_f32_16x16x32_bf16 v[44:47], v[148:151], v[84:87], v[44:47]
  s_setprio 3
  s_add_u32 s36, s27, 12
  v_mov_b32 v160, s36
L_lw_41:
  ds_read_b32 v161, v160
  s_waitcnt lgkmcnt(0)
  v_readfirstlane_b32 s36, v161
  s_nop 3
  s_cmp_ge_u32 s36, 1
  s_cbranch_scc1 L_lw_41_ok
  s_sleep 2
  s_branch L_lw_41
L_lw_41_ok:
  s_lshr_b32 s40, s3, 1
  s_and_b32 s41, s3, 1
  s_mul_i32 s40, s40, 96
  s_lshl_b32 s42, s41, 5
  s_add_u32 s42, s42, s40
  s_lshl_b32 s43, s41, 4
  s_add_u32 s43, s43, s40
  s_add_u32 s43, s43, 64
  v_lshlrev_b32 v5, 3, v3
  v_add_u32 v5, s42, v5
  v_lshlrev_b32 v6, 2, v3
  v_add_u32 v6, s43, v6
  s_mov_b32 s40, 155648
  s_mov_b32 s41, 158720
  v_lshl_add_u32 v7, v5, 2, s40
  ds_read_b128 v[56:59], v7 offset:0
  ds_read_b128 v[60:63], v7 offset:16
  v_lshl_add_u32 v7, v6, 2, s40
  ds_read_b128 v[64:67], v7
  v_lshl_add_u32 v7, v5, 1, s41
  ds_read_b128 v[80:83], v7
  v_lshl_add_u32 v7, v6, 1, s41
  ds_read_b64 v[84:85], v7
  v_lshlrev_b32 v5, 3, v4
  v_add_u32 v5, 147456, v5
  ds_read_b64 v[160:161], v5 offset:0
  ds_read_b64 v[162:163], v5 offset:128
  ds_read_b64 v[164:165], v5 offset:256
  ds_read_b64 v[166:167], v5 offset:384
  s_bfe_u32 s40, s3, 0x10001
  s_and_b32 s41, s3, 1
  s_mul_i32 s40, s40, 3
  s_sub_u32 s40, s40, s35
  s_add_u32 s40, s40, 6
  s_lshr_b32 s55, s3, 2
  s_mul_i32 s54, s55, 6
  s_add_u32 s42, s40, s41
  s_sub_u32 s44, s42, 6
  s_cmp_ge_u32 s42, 6
  s_cselect_b32 s42, s44, s42
  s_add_u32 s42, s42, s54
  s_lshl_b32 s42, s42, 12
  s_add_u32 s42, s42, 73728
  s_add_u32 s43, s40, 2
  s_sub_u32 s44, s43, 6
  s_cmp_ge_u32 s43, 6
  s_cselect_b32 s43, s44, s43
  s_add_u32 s43, s43, s54
  s_lshl_b32 s43, s43, 12
  s_lshl_b32 s41, s41, 3
  s_add_u32 s43, s43, s41
  s_add_u32 s43, s43, 73728
  v_add_u32 v5, s42, v2
  v_add_u32 v6, s43, v2
  s_mov_b32 s44, 0xbdd2d3e8
  v_mov_b32 v7, 0xc0135761
  s_waitcnt lgkmcnt(0)
  v_lshlrev_b32 v68, 16, v80
  v_and_b32 v69, 0xffff0000, v80
  v_lshlrev_b32 v70, 16, v81
  v_and_b32 v71, 0xffff0000, v81
  v_lshlrev_b32 v72, 16, v82
  v_and_b32 v73, 0xffff0000, v82
  v_lshlrev_b32 v74, 16, v83
  v_and_b32 v75, 0xffff0000, v83
  v_lshlrev_b32 v76, 16, v84
  v_and_b32 v77, 0xffff0000, v84
  v_lshlrev_b32 v78, 16, v85
  v_and_b32 v79, 0xffff0000, v85
  v_fma_f32 v80, v161, v56, v68
  v_fma_f32 v81, v161, v57, v69
  v_fma_f32 v82, v161, v58, v70
  v_fma_f32 v83, v161, v59, v71
  v_fma_f32 v84, v161, v60, v72
  v_fma_f32 v85, v161, v61, v73
  v_fma_f32 v86, v161, v62, v74
  v_fma_f32 v87, v161, v63, v75
  v_fma_f32 v8, v8, v160, v80
  v_fma_f32 v9, v9, v160, v81
  v_fma_f32 v10, v10, v160, v82
  v_fma_f32 v11, v11, v160, v83
  v_fma_f32 v12, v12, v160, v84
  v_fma_f32 v13, v13, v160, v85
  v_fma_f32 v14, v14, v160, v86
  v_fma_f32 v15, v15, v160, v87
  v_mul_f32 v80, v8, v8
  v_mul_f32 v81, v9, v9
  v_mul_f32 v82, v10, v10
  v_mul_f32 v83, v11, v11
  v_mul_f32 v84, v12, v12
  v_mul_f32 v85, v13, v13
  v_mul_f32 v86, v14, v14
  v_mul_f32 v87, v15, v15
  v_fma_f32 v80, v80, s44, v7
  v_fma_f32 v81, v81, s44, v7
  v_fma_f32 v82, v82, s44, v7
  v_fma_f32 v83, v83, s44, v7
  v_fma_f32 v84, v84, s44, v7
  v_fma_f32 v85, v85, s44, v7
  v_fma_f32 v86, v86, s44, v7
  v_fma_f32 v87, v87, s44, v7
  v_mul_f32 v80, v80, v8
  v_mul_f32 v81, v81, v9
  v_mul_f32 v82, v82, v10
  v_mul_f32 v83, v83, v11
  v_mul_f32 v84, v84, v12
  v_mul_f32 v85, v85, v13
  v_mul_f32 v86, v86, v14
  v_mul_f32 v87, v87, v15
  v_exp_f32 v80, v80
  v_exp_f32 v81, v81
  v_exp_f32 v82, v82
  v_exp_f32 v83, v83
  v_exp_f32 v84, v84
  v_exp_f32 v85, v85
  v_exp_f32 v86, v86
  v_exp_f32 v87, v87
  v_add_f32 v80, 1.0, v80
  v_add_f32 v81, 1.0, v81
  v_add_f32 v82, 1.0, v82
  v_add_f32 v83, 1.0, v83
  v_add_f32 v84, 1.0, v84
  v_add_f32 v85, 1.0, v85
  v_add_f32 v86, 1.0, v86
  v_add_f32 v87, 1.0, v87
  v_rcp_f32 v80, v80
  v_rcp_f32 v81, v81
  v_rcp_f32 v82, v82
  v_rcp_f32 v83, v83
  v_rcp_f32 v84, v84
  v_rcp_f32 v85, v85
  v_rcp_f32 v86, v86
  v_rcp_f32 v87, v87
  v_mul_f32 v80, v80, v8
  v_mul_f32 v81, v81, v9
  v_mul_f32 v82, v82, v10
  v_mul_f32 v83, v83, v11
  v_mul_f32 v84, v84, v12
  v_mul_f32 v85, v85, v13
  v_mul_f32 v86, v86, v14
  v_mul_f32 v87, v87, v15
  v_cvt_pk_bf16_f32 v8, v80, v81
  v_cvt_pk_bf16_f32 v9, v82, v83
  v_cvt_pk_bf16_f32 v10, v84, v85
  v_cvt_pk_bf16_f32 v11, v86, v87
  ds_write_b128 v5, v[8:11] offset:0
  s_mov_b32 s47, s49
  s_mul_i32 s48, s35, 3072
  s_add_u32 s48, s48, s47
  s_add_u32 s49, s47, 18432
  buffer_load_dwordx4 v[88:91], v2, s[8:11], s48 offen offset:0 sc1
  buffer_load_dwordx4 v[92:95], v2, s[8:11], s48 offen offset:1024 sc1
  buffer_load_dwordx4 v[96:99], v2, s[8:11], s48 offen offset:2048 sc1
  s_add_u32 s48, s48, 3072
  s_cmp_eq_u32 s48, s49
  s_cselect_b32 s48, s47, s48
  v_fma_f32 v80, v161, v64, v76
  v_fma_f32 v81, v161, v65, v77
  v_fma_f32 v82, v161, v66, v78
  v_fma_f32 v83, v161, v67, v79
  v_fma_f32 v16, v16, v160, v80
  v_fma_f32 v17, v17, v160, v81
  v_fma_f32 v18, v18, v160, v82
  v_fma_f32 v19, v19, v160, v83
  v_mul_f32 v80, v16, v16
  v_mul_f32 v81, v17, v17
  v_mul_f32 v82, v18, v18
  v_mul_f32 v83, v19, v19
  v_fma_f32 v80, v80, s44, v7
  v_fma_f32 v81, v81, s44, v7
  v_fma_f32 v82, v82, s44, v7
  v_fma_f32 v83, v83, s44, v7
  v_mul_f32 v80, v80, v16
  v_mul_f32 v81, v81, v17
  v_mul_f32 v82, v82, v18
  v_mul_f32 v83, v83, v19
  v_exp_f32 v80, v80
  v_exp_f32 v81, v81
  v_exp_f32 v82, v82
  v_exp_f32 v83, v83
  v_add_f32 v80, 1.0, v80
  v_add_f32 v81, 1.0, v81
  v_add_f32 v82, 1.0, v82
  v_add_f32 v83, 1.0, v83
  v_rcp_f32 v80, v80
  v_rcp_f32 v81, v81
  v_rcp_f32 v82, v82
  v_rcp_f32 v83, v83
  v_mul_f32 v80, v80, v16
  v_mul_f32 v81, v81, v17
  v_mul_f32 v82, v82, v18
  v_mul_f32 v83, v83, v19
  v_cvt_pk_bf16_f32 v16, v80, v81
  v_cvt_pk_bf16_f32 v17, v82, v83
  ds_write_b64 v6, v[16:17] offset:0
  buffer_load_dwordx4 v[100:103], v2, s[8:11], s48 offen offset:0 sc1
  buffer_load_dwordx4 v[104:107], v2, s[8:11], s48 offen offset:1024 sc1
  buffer_load_dwordx4 v[108:111], v2, s[8:11], s48 offen offset:2048 sc1
  s_add_u32 s48, s48, 3072
  s_cmp_eq_u32 s48, s49
  s_cselect_b32 s48, s47, s48
  v_fma_f32 v80, v163, v56, v68
  v_fma_f32 v81, v163, v57, v69
  v_fma_f32 v82, v163, v58, v70
  v_fma_f32 v83, v163, v59, v71
  v_fma_f32 v84, v163, v60, v72
  v_fma_f32 v85, v163, v61, v73
  v_fma_f32 v86, v163, v62, v74
  v_fma_f32 v87, v163, v63, v75
  v_fma_f32 v20, v20, v162, v80
  v_fma_f32 v21, v21, v162, v81
  v_fma_f32 v22, v22, v162, v82
  v_fma_f32 v23, v23, v162, v83
  v_fma_f32 v24, v24, v162, v84
  v_fma_f32 v25, v25, v162, v85
  v_fma_f32 v26, v26, v162, v86
  v_fma_f32 v27, v27, v162, v87
  v_mul_f32 v80, v20, v20
  v_mul_f32 v81, v21, v21
  v_mul_f32 v82, v22, v22
  v_mul_f32 v83, v23, v23
  v_mul_f32 v84, v24, v24
  v_mul_f32 v85, v25, v25
  v_mul_f32 v86, v26, v26
  v_mul_f32 v87, v27, v27
  v_fma_f32 v80, v80, s44, v7
  v_fma_f32 v81, v81, s44, v7
  v_fma_f32 v82, v82, s44, v7
  v_fma_f32 v83, v83, s44, v7
  v_fma_f32 v84, v84, s44, v7
  v_fma_f32 v85, v85, s44, v7
  v_fma_f32 v86, v86, s44, v7
  v_fma_f32 v87, v87, s44, v7
  v_mul_f32 v80, v80, v20
  v_mul_f32 v81, v81, v21
  v_mul_f32 v82, v82, v22
  v_mul_f32 v83, v83, v23
  v_mul_f32 v84, v84, v24
  v_mul_f32 v85, v85, v25
  v_mul_f32 v86, v86, v26
  v_mul_f32 v87, v87, v27
  v_exp_f32 v80, v80
  v_exp_f32 v81, v81
  v_exp_f32 v82, v82
  v_exp_f32 v83, v83
  v_exp_f32 v84, v84
  v_exp_f32 v85, v85
  v_exp_f32 v86, v86
  v_exp_f32 v87, v87
  v_add_f32 v80, 1.0, v80
  v_add_f32 v81, 1.0, v81
  v_add_f32 v82, 1.0, v82
  v_add_f32 v83, 1.0, v83
  v_add_f32 v84, 1.0, v84
  v_add_f32 v85, 1.0, v85
  v_add_f32 v86, 1.0, v86
  v_add_f32 v87, 1.0, v87
  v_rcp_f32 v80, v80
  v_rcp_f32 v81, v81
  v_rcp_f32 v82, v82
  v_rcp_f32 v83, v83
  v_rcp_f32 v84, v84
  v_rcp_f32 v85, v85
  v_rcp_f32 v86, v86
  v_rcp_f32 v87, v87
  v_mul_f32 v80, v80, v20
  v_mul_f32 v81, v81, v21
  v_mul_f32 v82, v82, v22
  v_mul_f32 v83, v83, v23
  v_mul_f32 v84, v84, v24
  v_mul_f32 v85, v85, v25
  v_mul_f32 v86, v86, v26
  v_mul_f32 v87, v87, v27
  v_cvt_pk_bf16_f32 v20, v80, v81
  v_cvt_pk_bf16_f32 v21, v82, v83
  v_cvt_pk_bf16_f32 v22, v84, v85
  v_cvt_pk_bf16_f32 v23, v86, v87
  ds_write_b128 v5, v[20:23] offset:1024
  buffer_load_dwordx4 v[112:115], v2, s[8:11], s48 offen offset:0 sc1
  buffer_load_dwordx4 v[116:119], v2, s[8:11], s48 offen offset:1024 sc1
  buffer_load_dwordx4 v[120:123], v2, s[8:11], s48 offen offset:2048 sc1
  s_add_u32 s48, s48, 3072
  s_cmp_eq_u32 s48, s49
  s_cselect_b32 s48, s47, s48
  v_fma_f32 v80, v163, v64, v76
  v_fma_f32 v81, v163, v65, v77
  v_fma_f32 v82, v163, v66, v78
  v_fma_f32 v83, v163, v67, v79
  v_fma_f32 v28, v28, v162, v80
  v_fma_f32 v29, v29, v162, v81
  v_fma_f32 v30, v30, v162, v82
  v_fma_f32 v31, v31, v162, v83
  v_mul_f32 v80, v28, v28
  v_mul_f32 v81, v29, v29
  v_mul_f32 v82, v30, v30
  v_mul_f32 v83, v31, v31
  v_fma_f32 v80, v80, s44, v7
  v_fma_f32 v81, v81, s44, v7
  v_fma_f32 v82, v82, s44, v7
  v_fma_f32 v83, v83, s44, v7
  v_mul_f32 v80, v80, v28
  v_mul_f32 v81, v81, v29
  v_mul_f32 v82, v82, v30
  v_mul_f32 v83, v83, v31
  v_exp_f32 v80, v80
  v_exp_f32 v81, v81
  v_exp_f32 v82, v82
  v_exp_f32 v83, v83
  v_add_f32 v80, 1.0, v80
  v_add_f32 v81, 1.0, v81
  v_add_f32 v82, 1.0, v82
  v_add_f32 v83, 1.0, v83
  v_rcp_f32 v80, v80
  v_rcp_f32 v81, v81
  v_rcp_f32 v82, v82
  v_rcp_f32 v83, v83
  v_mul_f32 v80, v80, v28
  v_mul_f32 v81, v81, v29
  v_mul_f32 v82, v82, v30
  v_mul_f32 v83, v83, v31
  v_cvt_pk_bf16_f32 v28, v80, v81
  v_cvt_pk_bf16_f32 v29, v82, v83
  ds_write_b64 v6, v[28:29] offset:1024
  buffer_load_dwordx4 v[124:127], v2, s[8:11], s48 offen offset:0 sc1
  buffer_load_dwordx4 v[128:131], v2, s[8:11], s48 offen offset:1024 sc1
  buffer_load_dwordx4 v[132:135], v2, s[8:11], s48 offen offset:2048 sc1
  s_add_u32 s48, s48, 3072
  s_cmp_eq_u32 s48, s49
  s_cselect_b32 s48, s47, s48
  v_fma_f32 v80, v165, v56, v68
  v_fma_f32 v81, v165, v57, v69
  v_fma_f32 v82, v165, v58, v70
  v_fma_f32 v83, v165, v59, v71
  v_fma_f32 v84, v165, v60, v72
  v_fma_f32 v85, v165, v61, v73
  v_fma_f32 v86, v165, v62, v74
  v_fma_f32 v87, v165, v63, v75
  v_fma_f32 v32, v32, v164, v80
  v_fma_f32 v33, v33, v164, v81
  v_fma_f32 v34, v34, v164, v82
  v_fma_f32 v35, v35, v164, v83
  v_fma_f32 v36, v36, v164, v84
  v_fma_f32 v37, v37, v164, v85
  v_fma_f32 v38, v38, v164, v86
  v_fma_f32 v39, v39, v164, v87
  v_mul_f32 v80, v32, v32
  v_mul_f32 v81, v33, v33
  v_mul_f32 v82, v34, v34
  v_mul_f32 v83, v35, v35
  v_mul_f32 v84, v36, v36
  v_mul_f32 v85, v37, v37
  v_mul_f32 v86, v38, v38
  v_mul_f32 v87, v39, v39
  v_fma_f32 v80, v80, s44, v7
  v_fma_f32 v81, v81, s44, v7
  v_fma_f32 v82, v82, s44, v7
  v_fma_f32 v83, v83, s44, v7
  v_fma_f32 v84, v84, s44, v7
  v_fma_f32 v85, v85, s44, v7
  v_fma_f32 v86, v86, s44, v7
  v_fma_f32 v87, v87, s44, v7
  v_mul_f32 v80, v80, v32
  v_mul_f32 v81, v81, v33
  v_mul_f32 v82, v82, v34
  v_mul_f32 v83, v83, v35
  v_mul_f32 v84, v84, v36
  v_mul_f32 v85, v85, v37
  v_mul_f32 v86, v86, v38
  v_mul_f32 v87, v87, v39
  v_exp_f32 v80, v80
  v_exp_f32 v81, v81
  v_exp_f32 v82, v82
  v_exp_f32 v83, v83
  v_exp_f32 v84, v84
  v_exp_f32 v85, v85
  v_exp_f32 v86, v86
  v_exp_f32 v87, v87
  v_add_f32 v80, 1.0, v80
  v_add_f32 v81, 1.0, v81
  v_add_f32 v82, 1.0, v82
  v_add_f32 v83, 1.0, v83
  v_add_f32 v84, 1.0, v84
  v_add_f32 v85, 1.0, v85
  v_add_f32 v86, 1.0, v86
  v_add_f32 v87, 1.0, v87
  v_rcp_f32 v80, v80
  v_rcp_f32 v81, v81
  v_rcp_f32 v82, v82
  v_rcp_f32 v83, v83
  v_rcp_f32 v84, v84
  v_rcp_f32 v85, v85
  v_rcp_f32 v86, v86
  v_rcp_f32 v87, v87
  v_mul_f32 v80, v80, v32
  v_mul_f32 v81, v81, v33
  v_mul_f32 v82, v82, v34
  v_mul_f32 v83, v83, v35
  v_mul_f32 v84, v84, v36
  v_mul_f32 v85, v85, v37
  v_mul_f32 v86, v86, v38
  v_mul_f32 v87, v87, v39
  v_cvt_pk_bf16_f32 v32, v80, v81
  v_cvt_pk_bf16_f32 v33, v82, v83
  v_cvt_pk_bf16_f32 v34, v84, v85
  v_cvt_pk_bf16_f32 v35, v86, v87
  ds_write_b128 v5, v[32:35] offset:2048
  buffer_load_dwordx4 v[136:139], v2, s[8:11], s48 offen offset:0 sc1
  buffer_load_dwordx4 v[140:143], v2, s[8:11], s48 offen offset:1024 sc1
  buffer_load_dwordx4 v[144:147], v2, s[8:11], s48 offen offset:2048 sc1
  s_add_u32 s48, s48, 3072
  s_cmp_eq_u32 s48, s49
  s_cselect_b32 s48, s47, s48
  v_fma_f32 v80, v165, v64, v76
  v_fma_f32 v81, v165, v65, v77
  v_fma_f32 v82, v165, v66, v78
  v_fma_f32 v83, v165, v67, v79
  v_fma_f32 v40, v40, v164, v80
  v_fma_f32 v41, v41, v164, v81
  v_fma_f32 v42, v42, v164, v82
  v_fma_f32 v43, v43, v164, v83
  v_mul_f32 v80, v40, v40
  v_mul_f32 v81, v41, v41
  v_mul_f32 v82, v42, v42
  v_mul_f32 v83, v43, v43
  v_fma_f32 v80, v80, s44, v7
  v_fma_f32 v81, v81, s44, v7
  v_fma_f32 v82, v82, s44, v7
  v_fma_f32 v83, v83, s44, v7
  v_mul_f32 v80, v80, v40
  v_mul_f32 v81, v81, v41
  v_mul_f32 v82, v82, v42
  v_mul_f32 v83, v83, v43
  v_exp_f32 v80, v80
  v_exp_f32 v81, v81
  v_exp_f32 v82, v82
  v_exp_f32 v83, v83
  v_add_f32 v80, 1.0, v80
  v_add_f32 v81, 1.0, v81
  v_add_f32 v82, 1.0, v82
  v_add_f32 v83, 1.0, v83
  v_rcp_f32 v80, v80
  v_rcp_f32 v81, v81
  v_rcp_f32 v82, v82
  v_rcp_f32 v83, v83
  v_mul_f32 v80, v80, v40
  v_mul_f32 v81, v81, v41
  v_mul_f32 v82, v82, v42
  v_mul_f32 v83, v83, v43
  v_cvt_pk_bf16_f32 v40, v80, v81
  v_cvt_pk_bf16_f32 v41, v82, v83
  ds_write_b64 v6, v[40:41] offset:2048
  buffer_load_dwordx4 v[148:151], v2, s[8:11], s48 offen offset:0 sc1
  buffer_load_dwordx4 v[152:155], v2, s[8:11], s48 offen offset:1024 sc1
  buffer_load_dwordx4 v[156:159], v2, s[8:11], s48 offen offset:2048 sc1
  s_add_u32 s48, s48, 3072
  s_cmp_eq_u32 s48, s49
  s_cselect_b32 s48, s47, s48
  v_fma_f32 v80, v167, v56, v68
  v_fma_f32 v81, v167, v57, v69
  v_fma_f32 v82, v167, v58, v70
  v_fma_f32 v83, v167, v59, v71
  v_fma_f32 v84, v167, v60, v72
  v_fma_f32 v85, v167, v61, v73
  v_fma_f32 v86, v167, v62, v74
  v_fma_f32 v87, v167, v63, v75
  v_fma_f32 v44, v44, v166, v80
  v_fma_f32 v45, v45, v166, v81
  v_fma_f32 v46, v46, v166, v82
  v_fma_f32 v47, v47, v166, v83
  v_fma_f32 v48, v48, v166, v84
  v_fma_f32 v49, v49, v166, v85
  v_fma_f32 v50, v50, v166, v86
  v_fma_f32 v51, v51, v166, v87
  v_mul_f32 v80, v44, v44
  v_mul_f32 v81, v45, v45
  v_mul_f32 v82, v46, v46
  v_mul_f32 v83, v47, v47
  v_mul_f32 v84, v48, v48
  v_mul_f32 v85, v49, v49
  v_mul_f32 v86, v50, v50
  v_mul_f32 v87, v51, v51
  v_fma_f32 v80, v80, s44, v7
  v_fma_f32 v81, v81, s44, v7
  v_fma_f32 v82, v82, s44, v7
  v_fma_f32 v83, v83, s44, v7
  v_fma_f32 v84, v84, s44, v7
  v_fma_f32 v85, v85, s44, v7
  v_fma_f32 v86, v86, s44, v7
  v_fma_f32 v87, v87, s44, v7
  v_mul_f32 v80, v80, v44
  v_mul_f32 v81, v81, v45
  v_mul_f32 v82, v82, v46
  v_mul_f32 v83, v83, v47
  v_mul_f32 v84, v84, v48
  v_mul_f32 v85, v85, v49
  v_mul_f32 v86, v86, v50
  v_mul_f32 v87, v87, v51
  v_exp_f32 v80, v80
  v_exp_f32 v81, v81
  v_exp_f32 v82, v82
  v_exp_f32 v83, v83
  v_exp_f32 v84, v84
  v_exp_f32 v85, v85
  v_exp_f32 v86, v86
  v_exp_f32 v87, v87
  v_add_f32 v80, 1.0, v80
  v_add_f32 v81, 1.0, v81
  v_add_f32 v82, 1.0, v82
  v_add_f32 v83, 1.0, v83
  v_add_f32 v84, 1.0, v84
  v_add_f32 v85, 1.0, v85
  v_add_f32 v86, 1.0, v86
  v_add_f32 v87, 1.0, v87
  v_rcp_f32 v80, v80
  v_rcp_f32 v81, v81
  v_rcp_f32 v82, v82
  v_rcp_f32 v83, v83
  v_rcp_f32 v84, v84
  v_rcp_f32 v85, v85
  v_rcp_f32 v86, v86
  v_rcp_f32 v87, v87
  v_mul_f32 v80, v80, v44
  v_mul_f32 v81, v81, v45
  v_mul_f32 v82, v82, v46
  v_mul_f32 v83, v83, v47
  v_mul_f32 v84, v84, v48
  v_mul_f32 v85, v85, v49
  v_mul_f32 v86, v86, v50
  v_mul_f32 v87, v87, v51
  v_cvt_pk_bf16_f32 v44, v80, v81
  v_cvt_pk_bf16_f32 v45, v82, v83
  v_cvt_pk_bf16_f32 v46, v84, v85
  v_cvt_pk_bf16_f32 v47, v86, v87
  ds_write_b128 v5, v[44:47] offset:3072
  v_fma_f32 v80, v167, v64, v76
  v_fma_f32 v81, v167, v65, v77
  v_fma_f32 v82, v167, v66, v78
  v_fma_f32 v83, v167, v67, v79
  v_fma_f32 v52, v52, v166, v80
  v_fma_f32 v53, v53, v166, v81
  v_fma_f32 v54, v54, v166, v82
  v_fma_f32 v55, v55, v166, v83
  v_mul_f32 v80, v52, v52
  v_mul_f32 v81, v53, v53
  v_mul_f32 v82, v54, v54
  v_mul_f32 v83, v55, v55
  v_fma_f32 v80, v80, s44, v7
  v_fma_f32 v81, v81, s44, v7
  v_fma_f32 v82, v82, s44, v7
  v_fma_f32 v83, v83, s44, v7
  v_mul_f32 v80, v80, v52
  v_mul_f32 v81, v81, v53
  v_mul_f32 v82, v82, v54
  v_mul_f32 v83, v83, v55
  v_exp_f32 v80, v80
  v_exp_f32 v81, v81
  v_exp_f32 v82, v82
  v_exp_f32 v83, v83
  v_add_f32 v80, 1.0, v80
  v_add_f32 v81, 1.0, v81
  v_add_f32 v82, 1.0, v82
  v_add_f32 v83, 1.0, v83
  v_rcp_f32 v80, v80
  v_rcp_f32 v81, v81
  v_rcp_f32 v82, v82
  v_rcp_f32 v83, v83
  v_mul_f32 v80, v80, v52
  v_mul_f32 v81, v81, v53
  v_mul_f32 v82, v82, v54
  v_mul_f32 v83, v83, v55
  v_cvt_pk_bf16_f32 v52, v80, v81
  v_cvt_pk_bf16_f32 v53, v82, v83
  ds_write_b64 v6, v[52:53] offset:3072
  v_add_u32 v5, 73728, v2
  v_add_u32 v6, 122880, v2
  s_lshl_b32 s55, s55, 2
  s_add_u32 s55, s55, s27
  s_add_u32 s55, s55, 20
  v_mov_b32 v162, s55
  v_mov_b32 v163, 1
  s_waitcnt lgkmcnt(0)
  s_mov_b64 exec, 1
  ds_add_u32 v162, v163
  s_mov_b64 exec, -1
  s_setprio 0
  s_add_u32 s36, s27, 20
  v_mov_b32 v160, s36
L_lw_42:
  ds_read_b32 v161, v160
  s_waitcnt lgkmcnt(0)
  v_readfirstlane_b32 s36, v161
  s_nop 3
  s_cmp_ge_u32 s36, 4
  s_cbranch_scc1 L_lw_42_ok
  s_sleep 2
  s_branch L_lw_42
L_lw_42_ok:
  ds_read_b128 v[56:59], v5 offset:0
  ds_read_b128 v[60:63], v5 offset:1024
  ds_read_b128 v[64:67], v5 offset:2048
  ds_read_b128 v[68:71], v5 offset:3072
  s_waitcnt vmcnt(15) lgkmcnt(0)
  v_mfma_f32_16x16x32_bf16 v[8:11], v[88:91], v[56:59], 0
  ds_read_b128 v[72:75], v5 offset:4096
  v_mfma_f32_16x16x32_bf16 v[12:15], v[92:95], v[56:59], 0
  v_mfma_f32_16x16x32_bf16 v[16:19], v[96:99], v[56:59], 0
  ds_read_b128 v[76:79], v5 offset:5120
  v_mfma_f32_16x16x32_bf16 v[28:31], v[96:99], v[60:63], 0
  v_mfma_f32_16x16x32_bf16 v[24:27], v[92:95], v[60:63], 0
  v_mfma_f32_16x16x32_bf16 v[20:23], v[88:91], v[60:63], 0
  ds_read_b128 v[80:83], v5 offset:6144
  v_mfma_f32_16x16x32_bf16 v[32:35], v[88:91], v[64:67], 0
  v_mfma_f32_16x16x32_bf16 v[36:39], v[92:95], v[64:67], 0
  v_mfma_f32_16x16x32_bf16 v[40:43], v[96:99], v[64:67], 0
  ds_read_b128 v[84:87], v5 offset:7168
  v_mfma_f32_16x16x32_bf16 v[52:55], v[96:99], v[68:71], 0
  v_mfma_f32_16x16x32_bf16 v[48:51], v[92:95], v[68:71], 0
  v_mfma_f32_16x16x32_bf16 v[44:47], v[88:91], v[68:71], 0
  s_waitcnt vmcnt(12) lgkmcnt(0)
  v_mfma_f32_16x16x32_bf16 v[8:11], v[100:103], v[72:75], v[8:11]
  ds_read_b128 v[56:59], v5 offset:8192
  v_mfma_f32_16x16x32_bf16 v[12:15], v[104:107], v[72:75], v[12:15]
  s_mov_b32 s47, s49
  s_mul_i32 s48, s35, 3072
  s_add_u32 s48, s48, s47
  s_add_u32 s49, s47, 18432
  buffer_load_dwordx4 v[88:91], v2, s[8:11], s48 offen offset:0 sc1
  v_mfma_f32_16x16x32_bf16 v[16:19], v[108:111], v[72:75], v[16:19]
  v_mfma_f32_16x16x32_bf16 v[28:31], v[108:111], v[76:79], v[28:31]
  ds_read_b128 v[60:63], v5 offset:9216
  v_mfma_f32_16x16x32_bf16 v[24:27], v[104:107], v[76:79], v[24:27]
  buffer_load_dwordx4 v[92:95], v2, s[8:11], s48 offen offset:1024 sc1
  v_mfma_f32_16x16x32_bf16 v[20:23], v[100:103], v[76:79], v[20:23]
  v_mfma_f32_16x16x32_bf16 v[32:35], v[100:103], v[80:83], v[32:35]
  ds_read_b128 v[64:67], v5 offset:10240
  v_mfma_f32_16x16x32_bf16 v[36:39], v[104:107], v[80:83], v[36:39]
  buffer_load_dwordx4 v[96:99], v2, s[8:11], s48 offen offset:2048 sc1
  s_add_u32 s48, s48, 3072
  s_cmp_eq_u32 s48, s49
  s_cselect_b32 s48, s47, s48
  v_mfma_f32_16x16x32_bf16 v[40:43], v[108:111], v[80:83], v[40:43]
  v_mfma_f32_16x16x32_bf16 v[52:55], v[108:111], v[84:87], v[52:55]
  ds_read_b128 v[68:71], v5 offset:11264
  v_mfma_f32_16x16x32_bf16 v[48:51], v[104:107], v[84:87], v[48:51]
  v_mfma_f32_16x16x32_bf16 v[44:47], v[100:103], v[84:87], v[44:47]
  s_waitcnt vmcnt(12) lgkmcnt(0)
  v_mfma_f32_16x16x32_bf16 v[8:11], v[112:115], v[56:59], v[8:11]
  ds_read_b128 v[72:75], v5 offset:12288
  v_mfma_f32_16x16x32_bf16 v[12:15], v[116:119], v[56:59], v[12:15]
  buffer_load_dwordx4 v[100:103], v2, s[8:11], s48 offen offset:0 sc1
  v_mfma_f32_16x16x32_bf16 v[16:19], v[120:123], v[56:59], v[16:19]
  v_mfma_f32_16x16x32_bf16 v[28:31], v[120:123], v[60:63], v[28:31]
  ds_read_b128 v[76:79], v5 offset:13312
  v_mfma_f32_16x16x32_bf16 v[24:27], v[116:119], v[60:63], v[24:27]
  buffer_load_dwordx4 v[104:107], v2, s[8:11], s48 offen offset:1024 sc1
  v_mfma_f32_16x16x32_bf16 v[20:23], v[112:115], v[60:63], v[20:23]
  v_mfma_f32_16x16x32_bf16 v[32:35], v[112:115], v[64:67], v[32:35]
  ds_read_b128 v[80:83], v5 offset:14336
  v_mfma_f32_16x16x32_bf16 v[36:39], v[116:119], v[64:67], v[36:39]
  buffer_load_dwordx4 v[108:111], v2, s[8:11], s48 offen offset:2048 sc1
  s_add_u32 s48, s48, 3072
  s_cmp_eq_u32 s48, s49
  s_cselect_b32 s48, s47, s48
  v_mfma_f32_16x16x32_bf16 v[40:43], v[120:123], v[64:67], v[40:43]
  v_mfma_f32_16x16x32_bf16 v[52:55], v[120:123], v[68:71], v[52:55]
  ds_read_b128 v[84:87], v5 offset:15360
  v_mfma_f32_16x16x32_bf16 v[48:51], v[116:119], v[68:71], v[48:51]
  v_mfma_f32_16x16x32_bf16 v[44:47], v[112:115], v[68:71], v[44:47]
  s_waitcnt vmcnt(12) lgkmcnt(0)
  v_mfma_f32_16x16x32_bf16 v[8:11], v[124:127], v[72:75], v[8:11]
  ds_read_b128 v[56:59], v5 offset:16384
  v_mfma_f32_16x16x32_bf16 v[12:15], v[128:131], v[72:75], v[12:15]
  buffer_load_dwordx4 v[112:115], v2, s[8:11], s48 offen offset:0 sc1
  v_mfma_f32_16x16x32_bf16 v[16:19], v[132:135], v[72:75], v[16:19]
  v_mfma_f32_16x16x32_bf16 v[28:31], v[132:135], v[76:79], v[28:31]
  ds_read_b128 v[60:63], v5 offset:17408
  v_mfma_f32_16x16x32_bf16 v[24:27], v[128:131], v[76:79], v[24:27]
  buffer_load_dwordx4 v[116:119], v2, s[8:11], s48 offen offset:1024 sc1
  v_mfma_f32_16x16x32_bf16 v[20:23], v[124:127], v[76:79], v[20:23]
  v_mfma_f32_16x16x32_bf16 v[32:35], v[124:127], v[80:83], v[32:35]
  ds_read_b128 v[64:67], v5 offset:18432
  v_mfma_f32_16x16x32_bf16 v[36:39], v[128:131], v[80:83], v[36:39]
  buffer_load_dwordx4 v[120:123], v2, s[8:11], s48 offen offset:2048 sc1
  s_add_u32 s48, s48, 3072
  s_cmp_eq_u32 s48, s49
  s_cselect_b32 s48, s47, s48
  v_mfma_f32_16x16x32_bf16 v[40:43], v[132:135], v[80:83], v[40:43]
  v_mfma_f32_16x16x32_bf16 v[52:55], v[132:135], v[84:87], v[52:55]
  ds_read_b128 v[68:71], v5 offset:19456
  v_mfma_f32_16x16x32_bf16 v[48:51], v[128:131], v[84:87], v[48:51]
  v_mfma_f32_16x16x32_bf16 v[44:47], v[124:127], v[84:87], v[44:47]
  s_waitcnt vmcnt(12) lgkmcnt(0)
  v_mfma_f32_16x16x32_bf16 v[8:11], v[136:139], v[56:59], v[8:11]
  ds_read_b128 v[72:75], v5 offset:20480
  v_mfma_f32_16x16x32_bf16 v[12:15], v[140:143], v[56:59], v[12:15]
  buffer_load_dwordx4 v[124:127], v2, s[8:11], s48 offen offset:0 sc1
  v_mfma_f32_16x16x32_bf16 v[16:19], v[144:147], v[56:59], v[16:19]
  v_mfma_f32_16x16x32_bf16 v[28:31], v[144:147], v[60:63], v[28:31]
  ds_read_b128 v[76:79], v5 offset:21504
  v_mfma_f32_16x16x32_bf16 v[24:27], v[140:143], v[60:63], v[24:27]
  buffer_load_dwordx4 v[128:131], v2, s[8:11], s48 offen offset:1024 sc1
  v_mfma_f32_16x16x32_bf16 v[20:23], v[136:139], v[60:63], v[20:23]
  v_mfma_f32_16x16x32_bf16 v[32:35], v[136:139], v[64:67], v[32:35]
  ds_read_b128 v[80:83], v5 offset:22528
  v_mfma_f32_16x16x32_bf16 v[36:39], v[140:143], v[64:67], v[36:39]
  buffer_load_dwordx4 v[132:135], v2, s[8:11], s48 offen offset:2048 sc1
  s_add_u32 s48, s48, 3072
  s_cmp_eq_u32 s48, s49
  s_cselect_b32 s48, s47, s48
  v_mfma_f32_16x16x32_bf16 v[40:43], v[144:147], v[64:67], v[40:43]
  v_mfma_f32_16x16x32_bf16 v[52:55], v[144:147], v[68:71], v[52:55]
  ds_read_b128 v[84:87], v5 offset:23552
  v_mfma_f32_16x16x32_bf16 v[48:51], v[140:143], v[68:71], v[48:51]
  v_mfma_f32_16x16x32_bf16 v[44:47], v[136:139], v[68:71], v[44:47]
  s_waitcnt vmcnt(12) lgkmcnt(0)
  v_mfma_f32_16x16x32_bf16 v[8:11], v[148:151], v[72:75], v[8:11]
  buffer_load_dwordx4 v[136:139], v2, s[8:11], s48 offen offset:0 sc1
  v_mfma_f32_16x16x32_bf16 v[12:15], v[152:155], v[72:75], v[12:15]
  v_mfma_f32_16x16x32_bf16 v[16:19], v[156:159], v[72:75], v[16:19]
  v_mfma_f32_16x16x32_bf16 v[28:31], v[156:159], v[76:79], v[28:31]
  buffer_load_dwordx4 v[140:143], v2, s[8:11], s48 offen offset:1024 sc1
  v_mfma_f32_16x16x32_bf16 v[24:27], v[152:155], v[76:79], v[24:27]
  v_mfma_f32_16x16x32_bf16 v[20:23], v[148:151], v[76:79], v[20:23]
  v_mfma_f32_16x16x32_bf16 v[32:35], v[148:151], v[80:83], v[32:35]
  v_mfma_f32_16x16x32_bf16 v[36:39], v[152:155], v[80:83], v[36:39]
  buffer_load_dwordx4 v[144:147], v2, s[8:11], s48 offen offset:2048 sc1
  s_add_u32 s48, s48, 3072
  s_cmp_eq_u32 s48, s49
  s_cselect_b32 s48, s47, s48
  v_mfma_f32_16x16x32_bf16 v[40:43], v[156:159], v[80:83], v[40:43]
  v_mfma_f32_16x16x32_bf16 v[52:55], v[156:159], v[84:87], v[52:55]
  v_mfma_f32_16x16x32_bf16 v[48:51], v[152:155], v[84:87], v[48:51]
  v_mfma_f32_16x16x32_bf16 v[44:47], v[148:151], v[84:87], v[44:47]
  buffer_load_dwordx4 v[148:151], v2, s[8:11], s48 offen offset:0 sc1
  buffer_load_dwordx4 v[152:155], v2, s[8:11], s48 offen offset:1024 sc1
  buffer_load_dwordx4 v[156:159], v2, s[8:11], s48 offen offset:2048 sc1
  s_add_u32 s48, s48, 3072
  s_cmp_eq_u32 s48, s49
  s_cselect_b32 s48, s47, s48
  s_add_u32 s36, s27, 24
  v_mov_b32 v160, s36
L_lw_43:
  ds_read_b32 v161, v160
  s_waitcnt lgkmcnt(0)
  v_readfirstlane_b32 s36, v161
  s_nop 3
  s_cmp_ge_u32 s36, 4
  s_cbranch_scc1 L_lw_43_ok
  s_sleep 2
  s_branch L_lw_43
L_lw_43_ok:
  ds_read_b128 v[56:59], v5 offset:24576
  ds_read_b128 v[60:63], v5 offset:25600
  ds_read_b128 v[64:67], v5 offset:26624
  ds_read_b128 v[68:71], v5 offset:27648
  s_waitcnt vmcnt(15) lgkmcnt(0)
  v_mfma_f32_16x16x32_bf16 v[8:11], v[88:91], v[56:59], v[8:11]
  ds_read_b128 v[72:75], v5 offset:28672
  v_mfma_f32_16x16x32_bf16 v[12:15], v[92:95], v[56:59], v[12:15]
  v_mfma_f32_16x16x32_bf16 v[16:19], v[96:99], v[56:59], v[16:19]
  ds_read_b128 v[76:79], v5 offset:29696
  v_mfma_f32_16x16x32_bf16 v[28:31], v[96:99], v[60:63], v[28:31]
  v_mfma_f32_16x16x32_bf16 v[24:27], v[92:95], v[60:63], v[24:27]
  v_mfma_f32_16x16x32_bf16 v[20:23], v[88:91], v[60:63], v[20:23]
  ds_read_b128 v[80:83], v5 offset:30720
  v_mfma_f32_16x16x32_bf16 v[32:35], v[88:91], v[64:67], v[32:35]
  v_mfma_f32_16x16x32_bf16 v[36:39], v[92:95], v[64:67], v[36:39]
  v_mfma_f32_16x16x32_bf16 v[40:43], v[96:99], v[64:67], v[40:43]
  ds_read_b128 v[84:87], v5 offset:31744
  v_mfma_f32_16x16x32_bf16 v[52:55], v[96:99], v[68:71], v[52:55]
  v_mfma_f32_16x16x32_bf16 v[48:51], v[92:95], v[68:71], v[48:51]
  v_mfma_f32_16x16x32_bf16 v[44:47], v[88:91], v[68:71], v[44:47]
  s_waitcnt vmcnt(12) lgkmcnt(0)
  v_mfma_f32_16x16x32_bf16 v[8:11], v[100:103], v[72:75], v[8:11]
  ds_read_b128 v[56:59], v5 offset:32768
  v_mfma_f32_16x16x32_bf16 v[12:15], v[104:107], v[72:75], v[12:15]
  s_mov_b32 s47, s49
  s_mul_i32 s48, s35, 3072
  s_add_u32 s48, s48, s47
  s_add_u32 s49, s47, 18432
  buffer_load_dwordx4 v[88:91], v2, s[8:11], s48 offen offset:0 sc1
  v_mfma_f32_16x16x32_bf16 v[16:19], v[108:111], v[72:75], v[16:19]
  v_mfma_f32_16x16x32_bf16 v[28:31], v[108:111], v[76:79], v[28:31]
  ds_read_b128 v[60:63], v5 offset:33792
  v_mfma_f32_16x16x32_bf16 v[24:27], v[104:107], v[76:79], v[24:27]
  buffer_load_dwordx4 v[92:95], v2, s[8:11], s48 offen offset:1024 sc1
  v_mfma_f32_16x16x32_bf16 v[20:23], v[100:103], v[76:79], v[20:23]
  v_mfma_f32_16x16x32_bf16 v[32:35], v[100:103], v[80:83], v[32:35]
  ds_read_b128 v[64:67], v5 offset:34816
  v_mfma_f32_16x16x32_bf16 v[36:39], v[104:107], v[80:83], v[36:39]
  buffer_load_dwordx4 v[96:99], v2, s[8:11], s48 offen offset:2048 sc1
  s_add_u32 s48, s48, 3072
  s_cmp_eq_u32 s48, s49
  s_cselect_b32 s48, s47, s48
  v_mfma_f32_16x16x32_bf16 v[40:43], v[108:111], v[80:83], v[40:43]
  v_mfma_f32_16x16x32_bf16 v[52:55], v[108:111], v[84:87], v[52:55]
  ds_read_b128 v[68:71], v5 offset:35840
  v_mfma_f32_16x16x32_bf16 v[48:51], v[104:107], v[84:87], v[48:51]
  v_mfma_f32_16x16x32_bf16 v[44:47], v[100:103], v[84:87], v[44:47]
  s_waitcnt vmcnt(12) lgkmcnt(0)
  v_mfma_f32_16x16x32_bf16 v[8:11], v[112:115], v[56:59], v[8:11]
  ds_read_b128 v[72:75], v5 offset:36864
  v_mfma_f32_16x16x32_bf16 v[12:15], v[116:119], v[56:59], v[12:15]
  buffer_load_dwordx4 v[100:103], v2, s[8:11], s48 offen offset:0 sc1
  v_mfma_f32_16x16x32_bf16 v[16:19], v[120:123], v[56:59], v[16:19]
  v_mfma_f32_16x16x32_bf16 v[28:31], v[120:123], v[60:63], v[28:31]
  ds_read_b128 v[76:79], v5 offset:37888
  v_mfma_f32_16x16x32_bf16 v[24:27], v[116:119], v[60:63], v[24:27]
  buffer_load_dwordx4 v[104:107], v2, s[8:11], s48 offen offset:1024 sc1
  v_mfma_f32_16x16x32_bf16 v[20:23], v[112:115], v[60:63], v[20:23]
  v_mfma_f32_16x16x32_bf16 v[32:35], v[112:115], v[64:67], v[32:35]
  ds_read_b128 v[80:83], v5 offset:38912
  v_mfma_f32_16x16x32_bf16 v[36:39], v[116:119], v[64:67], v[36:39]
  buffer_load_dwordx4 v[108:111], v2, s[8:11], s48 offen offset:2048 sc1
  s_add_u32 s48, s48, 3072
  s_cmp_eq_u32 s48, s49
  s_cselect_b32 s48, s47, s48
  v_mfma_f32_16x16x32_bf16 v[40:43], v[120:123], v[64:67], v[40:43]
  v_mfma_f32_16x16x32_bf16 v[52:55], v[120:123], v[68:71], v[52:55]
  ds_read_b128 v[84:87], v5 offset:39936
  v_mfma_f32_16x16x32_bf16 v[48:51], v[116:119], v[68:71], v[48:51]
  v_mfma_f32_16x16x32_bf16 v[44:47], v[112:115], v[68:71], v[44:47]
  s_waitcnt vmcnt(12) lgkmcnt(0)
  v_mfma_f32_16x16x32_bf16 v[8:11], v[124:127], v[72:75], v[8:11]
  ds_read_b128 v[56:59], v5 offset:40960
  v_mfma_f32_16x16x32_bf16 v[12:15], v[128:131], v[72:75], v[12:15]
  buffer_load_dwordx4 v[112:115], v2, s[8:11], s48 offen offset:0 sc1
  v_mfma_f32_16x16x32_bf16 v[16:19], v[132:135], v[72:75], v[16:19]
  v_mfma_f32_16x16x32_bf16 v[28:31], v[132:135], v[76:79], v[28:31]
  ds_read_b128 v[60:63], v5 offset:41984
  v_mfma_f32_16x16x32_bf16 v[24:27], v[128:131], v[76:79], v[24:27]
  buffer_load_dwordx4 v[116:119], v2, s[8:11], s48 offen offset:1024 sc1
  v_mfma_f32_16x16x32_bf16 v[20:23], v[124:127], v[76:79], v[20:23]
  v_mfma_f32_16x16x32_bf16 v[32:35], v[124:127], v[80:83], v[32:35]
  ds_read_b128 v[64:67], v5 offset:43008
  v_mfma_f32_16x16x32_bf16 v[36:39], v[128:131], v[80:83], v[36:39]
  buffer_load_dwordx4 v[120:123], v2, s[8:11], s48 offen offset:2048 sc1
  s_add_u32 s48, s48, 3072
  s_cmp_eq_u32 s48, s49
  s_cselect_b32 s48, s47, s48
  v_mfma_f32_16x16x32_bf16 v[40:43], v[132:135], v[80:83], v[40:43]
  v_mfma_f32_16x16x32_bf16 v[52:55], v[132:135], v[84:87], v[52:55]
  ds_read_b128 v[68:71], v5 offset:44032
  v_mfma_f32_16x16x32_bf16 v[48:51], v[128:131], v[84:87], v[48:51]
  v_mfma_f32_16x16x32_bf16 v[44:47], v[124:127], v[84:87], v[44:47]
  s_waitcnt vmcnt(12) lgkmcnt(0)
  v_mfma_f32_16x16x32_bf16 v[8:11], v[136:139], v[56:59], v[8:11]
  ds_read_b128 v[72:75], v5 offset:45056
  v_mfma_f32_16x16x32_bf16 v[12:15], v[140:143], v[56:59], v[12:15]
  buffer_load_dwordx4 v[124:127], v2, s[8:11], s48 offen offset:0 sc1
  v_mfma_f32_16x16x32_bf16 v[16:19], v[144:147], v[56:59], v[16:19]
  v_mfma_f32_16x16x32_bf16 v[28:31], v[144:147], v[60:63], v[28:31]
  ds_read_b128 v[76:79], v5 offset:46080
  v_mfma_f32_16x16x32_bf16 v[24:27], v[140:143], v[60:63], v[24:27]
  buffer_load_dwordx4 v[128:131], v2, s[8:11], s48 offen offset:1024 sc1
  v_mfma_f32_16x16x32_bf16 v[20:23], v[136:139], v[60:63], v[20:23]
  v_mfma_f32_16x16x32_bf16 v[32:35], v[136:139], v[64:67], v[32:35]
  ds_read_b128 v[80:83], v5 offset:47104
  v_mfma_f32_16x16x32_bf16 v[36:39], v[140:143], v[64:67], v[36:39]
  buffer_load_dwordx4 v[132:135], v2, s[8:11], s48 offen offset:2048 sc1
  s_add_u32 s48, s48, 3072
  s_cmp_eq_u32 s48, s49
  s_cselect_b32 s48, s47, s48
  v_mfma_f32_16x16x32_bf16 v[40:43], v[144:147], v[64:67], v[40:43]
  v_mfma_f32_16x16x32_bf16 v[52:55], v[144:147], v[68:71], v[52:55]
  ds_read_b128 v[84:87], v5 offset:48128
  v_mfma_f32_16x16x32_bf16 v[48:51], v[140:143], v[68:71], v[48:51]
  v_mfma_f32_16x16x32_bf16 v[44:47], v[136:139], v[68:71], v[44:47]
  s_waitcnt vmcnt(12) lgkmcnt(0)
  v_mfma_f32_16x16x32_bf16 v[8:11], v[148:151], v[72:75], v[8:11]
  buffer_load_dwordx4 v[136:139], v2, s[8:11], s48 offen offset:0 sc1
  v_mfma_f32_16x16x32_bf16 v[12:15], v[152:155], v[72:75], v[12:15]
  v_mfma_f32_16x16x32_bf16 v[16:19], v[156:159], v[72:75], v[16:19]
  v_mfma_f32_16x16x32_bf16 v[28:31], v[156:159], v[76:79], v[28:31]
  buffer_load_dwordx4 v[140:143], v2, s[8:11], s48 offen offset:1024 sc1
  v_mfma_f32_16x16x32_bf16 v[24:27], v[152:155], v[76:79], v[24:27]
  v_mfma_f32_16x16x32_bf16 v[20:23], v[148:151], v[76:79], v[20:23]
  v_mfma_f32_16x16x32_bf16 v[32:35], v[148:151], v[80:83], v[32:35]
  v_mfma_f32_16x16x32_bf16 v[36:39], v[152:155], v[80:83], v[36:39]
  buffer_load_dwordx4 v[144:147], v2, s[8:11], s48 offen offset:2048 sc1
  s_add_u32 s48, s48, 3072
  s_cmp_eq_u32 s48, s49
  s_cselect_b32 s48, s47, s48
  v_mfma_f32_16x16x32_bf16 v[40:43], v[156:159], v[80:83], v[40:43]
  v_mfma_f32_16x16x32_bf16 v[52:55], v[156:159], v[84:87], v[52:55]
  v_mfma_f32_16x16x32_bf16 v[48:51], v[152:155], v[84:87], v[48:51]
  v_mfma_f32_16x16x32_bf16 v[44:47], v[148:151], v[84:87], v[44:47]
  buffer_load_dwordx4 v[148:151], v2, s[8:11], s48 offen offset:0 sc1
  buffer_load_dwordx4 v[152:155], v2, s[8:11], s48 offen offset:1024 sc1
  buffer_load_dwordx4 v[156:159], v2, s[8:11], s48 offen offset:2048 sc1
  s_add_u32 s48, s48, 3072
  s_cmp_eq_u32 s48, s49
  s_cselect_b32 s48, s47, s48
  s_add_u32 s36, s27, 28
  v_mov_b32 v160, s36
L_lw_44:
  ds_read_b32 v161, v160
  s_waitcnt lgkmcnt(0)
  v_readfirstlane_b32 s36, v161
  s_nop 3
  s_cmp_ge_u32 s36, 4
  s_cbranch_scc1 L_lw_44_ok
  s_sleep 2
  s_branch L_lw_44
L_lw_44_ok:
  ds_read_b128 v[56:59], v6 offset:0
  ds_read_b128 v[60:63], v6 offset:1024
  ds_read_b128 v[64:67], v6 offset:2048
  ds_read_b128 v[68:71], v6 offset:3072
  s_waitcnt vmcnt(15) lgkmcnt(0)
  v_mfma_f32_16x16x32_bf16 v[8:11], v[88:91], v[56:59], v[8:11]
  ds_read_b128 v[72:75], v6 offset:4096
  v_mfma_f32_16x16x32_bf16 v[12:15], v[92:95], v[56:59], v[12:15]
  v_mfma_f32_16x16x32_bf16 v[16:19], v[96:99], v[56:59], v[16:19]
  ds_read_b128 v[76:79], v6 offset:5120
  v_mfma_f32_16x16x32_bf16 v[28:31], v[96:99], v[60:63], v[28:31]
  v_mfma_f32_16x16x32_bf16 v[24:27], v[92:95], v[60:63], v[24:27]
  v_mfma_f32_16x16x32_bf16 v[20:23], v[88:91], v[60:63], v[20:23]
  ds_read_b128 v[80:83], v6 offset:6144
  v_mfma_f32_16x16x32_bf16 v[32:35], v[88:91], v[64:67], v[32:35]
  v_mfma_f32_16x16x32_bf16 v[36:39], v[92:95], v[64:67], v[36:39]
  v_mfma_f32_16x16x32_bf16 v[40:43], v[96:99], v[64:67], v[40:43]
  ds_read_b128 v[84:87], v6 offset:7168
  v_mfma_f32_16x16x32_bf16 v[52:55], v[96:99], v[68:71], v[52:55]
  v_mfma_f32_16x16x32_bf16 v[48:51], v[92:95], v[68:71], v[48:51]
  v_mfma_f32_16x16x32_bf16 v[44:47], v[88:91], v[68:71], v[44:47]
  s_waitcnt vmcnt(12) lgkmcnt(0)
  v_mfma_f32_16x16x32_bf16 v[8:11], v[100:103], v[72:75], v[8:11]
  ds_read_b128 v[56:59], v6 offset:8192
  v_mfma_f32_16x16x32_bf16 v[12:15], v[104:107], v[72:75], v[12:15]
  v_mfma_f32_16x16x32_bf16 v[16:19], v[108:111], v[72:75], v[16:19]
  ds_read_b128 v[60:63], v6 offset:9216
  v_mfma_f32_16x16x32_bf16 v[28:31], v[108:111], v[76:79], v[28:31]
  v_mfma_f32_16x16x32_bf16 v[24:27], v[104:107], v[76:79], v[24:27]
  v_mfma_f32_16x16x32_bf16 v[20:23], v[100:103], v[76:79], v[20:23]
  ds_read_b128 v[64:67], v6 offset:10240
  v_mfma_f32_16x16x32_bf16 v[32:35], v[100:103], v[80:83], v[32:35]
  v_mfma_f32_16x16x32_bf16 v[36:39], v[104:107], v[80:83], v[36:39]
  v_mfma_f32_16x16x32_bf16 v[40:43], v[108:111], v[80:83], v[40:43]
  ds_read_b128 v[68:71], v6 offset:11264
  v_mfma_f32_16x16x32_bf16 v[52:55], v[108:111], v[84:87], v[52:55]
  v_mfma_f32_16x16x32_bf16 v[48:51], v[104:107], v[84:87], v[48:51]
  v_mfma_f32_16x16x32_bf16 v[44:47], v[100:103], v[84:87], v[44:47]
  s_waitcnt vmcnt(9) lgkmcnt(0)
  v_mfma_f32_16x16x32_bf16 v[8:11], v[112:115], v[56:59], v[8:11]
  ds_read_b128 v[72:75], v6 offset:12288
  v_mfma_f32_16x16x32_bf16 v[12:15], v[116:119], v[56:59], v[12:15]
  v_mfma_f32_16x16x32_bf16 v[16:19], v[120:123], v[56:59], v[16:19]
  ds_read_b128 v[76:79], v6 offset:13312
  v_mfma_f32_16x16x32_bf16 v[28:31], v[120:123], v[60:63], v[28:31]
  v_mfma_f32_16x16x32_bf16 v[24:27], v[116:119], v[60:63], v[24:27]
  v_mfma_f32_16x16x32_bf16 v[20:23], v[112:115], v[60:63], v[20:23]
  ds_read_b128 v[80:83], v6 offset:14336
  v_mfma_f32_16x16x32_bf16 v[32:35], v[112:115], v[64:67], v[32:35]
  v_mfma_f32_16x16x32_bf16 v[36:39], v[116:119], v[64:67], v[36:39]
  v_mfma_f32_16x16x32_bf16 v[40:43], v[120:123], v[64:67], v[40:43]
  ds_read_b128 v[84:87], v6 offset:15360
  v_mfma_f32_16x16x32_bf16 v[52:55], v[120:123], v[68:71], v[52:55]
  v_mfma_f32_16x16x32_bf16 v[48:51], v[116:119], v[68:71], v[48:51]
  v_mfma_f32_16x16x32_bf16 v[44:47], v[112:115], v[68:71], v[44:47]
  s_waitcnt vmcnt(6) lgkmcnt(0)
  v_mfma_f32_16x16x32_bf16 v[8:11], v[124:127], v[72:75], v[8:11]
  ds_read_b128 v[56:59], v6 offset:16384
  v_mfma_f32_16x16x32_bf16 v[12:15], v[128:131], v[72:75], v[12:15]
  v_mfma_f32_16x16x32_bf16 v[16:19], v[132:135], v[72:75], v[16:19]
  ds_read_b128 v[60:63], v6 offset:17408
  v_mfma_f32_16x16x32_bf16 v[28:31], v[132:135], v[76:79], v[28:31]
  v_mfma_f32_16x16x32_bf16 v[24:27], v[128:131], v[76:79], v[24:27]
  v_mfma_f32_16x16x32_bf16 v[20:23], v[124:127], v[76:79], v[20:23]
  ds_read_b128 v[64:67], v6 offset:18432
  v_mfma_f32_16x16x32_bf16 v[32:35], v[124:127], v[80:83], v[32:35]
  v_mfma_f32_16x16x32_bf16 v[36:39], v[128:131], v[80:83], v[36:39]
  v_mfma_f32_16x16x32_bf16 v[40:43], v[132:135], v[80:83], v[40:43]
  ds_read_b128 v[68:71], v6 offset:19456
  v_mfma_f32_16x16x32_bf16 v[52:55], v[132:135], v[84:87], v[52:55]
  v_mfma_f32_16x16x32_bf16 v[48:51], v[128:131], v[84:87], v[48:51]
  v_mfma_f32_16x16x32_bf16 v[44:47], v[124:127], v[84:87], v[44:47]
  s_waitcnt vmcnt(3) lgkmcnt(0)
  v_mfma_f32_16x16x32_bf16 v[8:11], v[136:139], v[56:59], v[8:11]
  ds_read_b128 v[72:75], v6 offset:20480
  v_mfma_f32_16x16x32_bf16 v[12:15], v[140:143], v[56:59], v[12:15]
  v_mfma_f32_16x16x32_bf16 v[16:19], v[144:147], v[56:59], v[16:19]
  ds_read_b128 v[76:79], v6 offset:21504
  v_mfma_f32_16x16x32_bf16 v[28:31], v[144:147], v[60:63], v[28:31]
  v_mfma_f32_16x16x32_bf16 v[24:27], v[140:143], v[60:63], v[24:27]
  v_mfma_f32_16x16x32_bf16 v[20:23], v[136:139], v[60:63], v[20:23]
  ds_read_b128 v[80:83], v6 offset:22528
  v_mfma_f32_16x16x32_bf16 v[32:35], v[136:139], v[64:67], v[32:35]
  v_mfma_f32_16x16x32_bf16 v[36:39], v[140:143], v[64:67], v[36:39]
  v_mfma_f32_16x16x32_bf16 v[40:43], v[144:147], v[64:67], v[40:43]
  ds_read_b128 v[84:87], v6 offset:23552
  v_mfma_f32_16x16x32_bf16 v[52:55], v[144:147], v[68:71], v[52:55]
  v_mfma_f32_16x16x32_bf16 v[48:51], v[140:143], v[68:71], v[48:51]
  v_mfma_f32_16x16x32_bf16 v[44:47], v[136:139], v[68:71], v[44:47]
  s_waitcnt vmcnt(0) lgkmcnt(0)
  v_mfma_f32_16x16x32_bf16 v[8:11], v[148:151], v[72:75], v[8:11]
  v_mfma_f32_16x16x32_bf16 v[12:15], v[152:155], v[72:75], v[12:15]
  v_mfma_f32_16x16x32_bf16 v[16:19], v[156:159], v[72:75], v[16:19]
  v_mfma_f32_16x16x32_bf16 v[28:31], v[156:159], v[76:79], v[28:31]
  v_mfma_f32_16x16x32_bf16 v[24:27], v[152:155], v[76:79], v[24:27]
  v_mfma_f32_16x16x32_bf16 v[20:23], v[148:151], v[76:79], v[20:23]
  v_mfma_f32_16x16x32_bf16 v[32:35], v[148:151], v[80:83], v[32:35]
  v_mfma_f32_16x16x32_bf16 v[36:39], v[152:155], v[80:83], v[36:39]
  v_mfma_f32_16x16x32_bf16 v[40:43], v[156:159], v[80:83], v[40:43]
  v_mfma_f32_16x16x32_bf16 v[52:55], v[156:159], v[84:87], v[52:55]
  v_mfma_f32_16x16x32_bf16 v[48:51], v[152:155], v[84:87], v[48:51]
  v_mfma_f32_16x16x32_bf16 v[44:47], v[148:151], v[84:87], v[44:47]
  s_setprio 0
  v_lshlrev_b32 v5, 10, v3
  v_lshl_add_u32 v5, v4, 4, v5
  v_lshrrev_b32 v6, 1, v3
  v_lshlrev_b32 v6, 10, v6
  v_and_b32 v7, 31, v1
  v_lshl_add_u32 v6, v7, 4, v6
  s_mul_i32 s40, s32, 2359296
  s_add_u32 s40, s40, s39
  s_mul_i32 s41, s3, 6144
  s_add_u32 s40, s40, s41
  s_add_u32 s40, s40, s26
  s_add_u32 s41, s40, 4096
  v_cvt_pk_bf16_f32 v56, v8, v9
  v_cvt_pk_bf16_f32 v57, v10, v11
  v_cvt_pk_bf16_f32 v58, v12, v13
  v_cvt_pk_bf16_f32 v59, v14, v15
  v_cvt_pk_bf16_f32 v72, v16, v17
  v_cvt_pk_bf16_f32 v73, v18, v19
  buffer_store_dwordx4 v[56:59], v5, s[8:11], s40 offen offset:0 sc1
  v_cvt_pk_bf16_f32 v60, v20, v21
  v_cvt_pk_bf16_f32 v61, v22, v23
  v_cvt_pk_bf16_f32 v62, v24, v25
  v_cvt_pk_bf16_f32 v63, v26, v27
  v_cvt_pk_bf16_f32 v74, v28, v29
  v_cvt_pk_bf16_f32 v75, v30, v31
  buffer_store_dwordx4 v[60:63], v5, s[8:11], s40 offen offset:256 sc1
  s_nop 0
  v_permlane16_swap_b32 v72, v74
  v_permlane16_swap_b32 v73, v75
  s_nop 0
  buffer_store_dwordx4 v[72:75], v6, s[8:11], s41 offen offset:0 sc1
  v_cvt_pk_bf16_f32 v64, v32, v33
  v_cvt_pk_bf16_f32 v65, v34, v35
  v_cvt_pk_bf16_f32 v66, v36, v37
  v_cvt_pk_bf16_f32 v67, v38, v39
  v_cvt_pk_bf16_f32 v76, v40, v41
  v_cvt_pk_bf16_f32 v77, v42, v43
  buffer_store_dwordx4 v[64:67], v5, s[8:11], s40 offen offset:512 sc1
  v_cvt_pk_bf16_f32 v68, v44, v45
  v_cvt_pk_bf16_f32 v69, v46, v47
  v_cvt_pk_bf16_f32 v70, v48, v49
  v_cvt_pk_bf16_f32 v71, v50, v51
  v_cvt_pk_bf16_f32 v78, v52, v53
  v_cvt_pk_bf16_f32 v79, v54, v55
  buffer_store_dwordx4 v[68:71], v5, s[8:11], s40 offen offset:768 sc1
  s_nop 0
  v_permlane16_swap_b32 v76, v78
  v_permlane16_swap_b32 v77, v79
  s_nop 0
  buffer_store_dwordx4 v[76:79], v6, s[8:11], s41 offen offset:512 sc1
  s_mul_i32 s40, s60, 24
  s_mul_i32 s41, s30, 3
  s_add_u32 s40, s40, s41
  s_add_u32 s40, s40, s61
  s_min_u32 s40, s40, 71
  s_lshl_b32 s40, s40, 4
  s_load_dwordx4 s[52:55], s[20:21], s40
  s_add_u32 s36, s27, 56
  v_mov_b32 v8, s36
  v_mov_b32 v9, 1
  s_mov_b64 exec, 1
  ds_add_u32 v8, v9
  s_mov_b64 exec, -1
  s_add_u32 s36, s27, 32
  s_lshl_b32 s37, s31, 10
  s_lshl_b32 s38, s32, 7
  s_add_u32 s37, s37, s38
  s_add_u32 s37, s37, s28
  s_add_u32 s37, s37, 65536
  s_lshl_b32 s38, s60, 2
  s_add_u32 s36, s36, s38
  s_lshl_b32 s38, s60, 15
  s_add_u32 s37, s37, s38
  s_waitcnt vmcnt(0)
  v_mov_b32 v8, s36
  v_mov_b32 v9, 1
  s_mov_b64 exec, 1
  ds_add_rtn_u32 v8, v8, v9
  s_waitcnt lgkmcnt(0)
  v_readfirstlane_b32 s36, v8
  v_mov_b32 v8, s62
  v_mov_b32 v9, s63
  v_lshlrev_b32 v10, 13, v1
  s_nop 0
  s_cmp_lg_u32 s36, 3
  s_cbranch_scc1 L_pub_45
  buffer_store_dwordx2 v[8:9], v10, s[8:11], s37 offen sc1
L_pub_45:
  s_mov_b64 exec, -1
  s_cmp_lg_u32 s61, 3
  s_cbranch_scc1 L_D_work
  s_cmp_lg_u32 s60, 0
  s_cbranch_scc1 L_D_g1
  s_add_u32 s36, s27, 36
  v_mov_b32 v8, s36
L_lw_46:
  ds_read_b32 v9, v8
  s_waitcnt lgkmcnt(0)
  v_readfirstlane_b32 s36, v9
  s_nop 3
  s_cmp_ge_u32 s36, 4
  s_cbranch_scc1 L_lw_46_ok
  s_sleep 8
  s_branch L_lw_46
L_lw_46_ok:
  s_branch L_D_g2
L_D_g1:
  s_add_u32 s36, s27, 56
  v_mov_b32 v8, s36
L_lw_47:
  ds_read_b32 v9, v8
  s_waitcnt lgkmcnt(0)
  v_readfirstlane_b32 s36, v9
  s_nop 3
  s_cmp_ge_u32 s36, 12
  s_cbranch_scc1 L_lw_47_ok
  s_sleep 4
  s_branch L_lw_47
L_lw_47_ok:
L_D_g2:
  s_add_u32 s36, s27, 32
  s_lshl_b32 s37, s60, 2
  s_add_u32 s36, s36, s37
  v_mov_b32 v8, s36
L_lw_48:
  ds_read_b32 v9, v8
  s_waitcnt lgkmcnt(0)
  v_readfirstlane_b32 s36, v9
  s_nop 3
  s_cmp_ge_u32 s36, 4
  s_cbranch_scc1 L_lw_48_ok
  s_sleep 1
  s_branch L_lw_48
L_lw_48_ok:
  s_lshl_b32 s39, s29, 10
  s_lshl_b32 s38, s60, 15
  s_add_u32 s39, s39, s38
  s_add_u32 s39, s39, s28
  s_add_u32 s37, s39, 65536
  v_lshlrev_b32 v8, 7, v1
  s_mov_b32 exec_lo, 0xff
  s_mov_b32 exec_hi, 0x0
  s_mov_b32 s38, 0x20000
L_aw_49:
  v_mov_b32 v12, 0
  v_mov_b32 v13, 0
  buffer_atomic_or_x2 v[12:13], v8, s[8:11], s37 offen sc0 sc1
  s_waitcnt vmcnt(0)
  v_cmp_ne_u64 vcc, s[62:63], v[12:13]
  s_sub_u32 s38, s38, 1
  s_nop 3
  s_cbranch_vccz L_aw_49_ok
  s_cmp_eq_u32 s38, 0
  s_cbranch_scc1 L_aw_49_ok
  s_sleep 3
  s_branch L_aw_49
L_aw_49_ok:
  s_mov_b64 exec, -1
  s_add_u32 s36, s27, 64
  s_lshl_b32 s37, s60, 2
  s_add_u32 s36, s36, s37
  v_mov_b32 v10, s36
  v_mov_b32 v11, 1
  s_mov_b64 exec, 1
  ds_add_u32 v10, v11
  s_mov_b64 exec, -1
  s_cmp_lg_u32 s22, 0
  s_cbranch_scc1 L_D_idle
  s_add_u32 s36, s27, 44
  s_lshl_b32 s37, s60, 2
  s_add_u32 s36, s36, s37
  v_mov_b32 v10, s36
L_lw_50:
  ds_read_b32 v11, v10
  s_waitcnt lgkmcnt(0)
  v_readfirstlane_b32 s36, v11
  s_nop 3
  s_cmp_ge_u32 s36, 3
  s_cbranch_scc1 L_lw_50_ok
  s_sleep 2
  s_branch L_lw_50
L_lw_50_ok:
  s_add_u32 s36, s27, 56
  v_mov_b32 v10, s36
L_lw_51:
  ds_read_b32 v11, v10
  s_waitcnt lgkmcnt(0)
  v_readfirstlane_b32 s36, v11
  s_nop 3
  s_cmp_ge_u32 s36, 12
  s_cbranch_scc1 L_lw_51_ok
  s_sleep 8
  s_branch L_lw_51
L_lw_51_ok:
  s_add_u32 s37, s39, 163840
  s_cmp_eq_u32 s29, 0
  s_cselect_b32 s38, 0, 1024
  s_sub_u32 s37, s37, s38
  s_sub_u32 s38, s38, 1024
  v_cmp_le_u32 vcc, 8, v1
  v_mov_b32 v9, s38
  s_nop 0
  v_cndmask_b32 v9, 0, v9, vcc
  v_add_u32 v8, v8, v9
  s_mov_b32 exec_lo, 0xffff
  s_mov_b32 exec_hi, 0x0
  s_mov_b32 s38, 0x20000
L_aw_52:
  v_mov_b32 v12, 0
  v_mov_b32 v13, 0
  buffer_atomic_or_x2 v[12:13], v8, s[8:11], s37 offen sc0 sc1
  s_waitcnt vmcnt(0)
  v_cmp_ne_u64 vcc, s[62:63], v[12:13]
  s_sub_u32 s38, s38, 1
  s_nop 3
  s_cbranch_vccz L_aw_52_ok
  s_cmp_eq_u32 s38, 0
  s_cbranch_scc1 L_aw_52_ok
  s_sleep 3
  s_branch L_aw_52
L_aw_52_ok:
  s_mov_b64 exec, -1
  s_add_u32 s36, s27, 80
  s_lshl_b32 s37, s60, 2
  s_add_u32 s36, s36, s37
  v_mov_b32 v10, s36
  v_mov_b32 v11, 1
  s_mov_b64 exec, 1
  ds_add_u32 v10, v11
  s_mov_b64 exec, -1
  s_waitcnt lgkmcnt(0)
  s_branch L_D_idle
L_D_work:
  s_mul_i32 s39, s29, 73728
  s_lshl_b32 s41, s40, 6
  s_add_u32 s41, s41, s39
  s_add_u32 s36, s27, 64
  s_lshl_b32 s37, s60, 2
  s_add_u32 s36, s36, s37
  v_mov_b32 v8, s36
L_lw_53:
  ds_read_b32 v9, v8
  s_waitcnt lgkmcnt(0)
  v_readfirstlane_b32 s36, v9
  s_nop 3
  s_cmp_ge_u32 s36, 1
  s_cbranch_scc1 L_lw_53_ok
  s_sleep 2
  s_branch L_lw_53
L_lw_53_ok:
  s_add_u32 s42, s41, s25
  buffer_load_dwordx4 v[40:43], v2, s[8:11], s42 offen sc1
  s_add_u32 s42, s41, s26
  buffer_load_dwordx4 v[8:11], v2, s[8:11], s42 offen sc1
  s_add_u32 s42, s42, 2359296
  buffer_load_dwordx4 v[12:15], v2, s[8:11], s42 offen sc1
  s_add_u32 s42, s42, 2359296
  buffer_load_dwordx4 v[16:19], v2, s[8:11], s42 offen sc1
  s_add_u32 s42, s42, 2359296
  buffer_load_dwordx4 v[20:23], v2, s[8:11], s42 offen sc1
  s_add_u32 s42, s42, 2359296
  buffer_load_dwordx4 v[24:27], v2, s[8:11], s42 offen sc1
  s_add_u32 s42, s42, 2359296
  buffer_load_dwordx4 v[28:31], v2, s[8:11], s42 offen sc1
  s_add_u32 s42, s42, 2359296
  buffer_load_dwordx4 v[32:35], v2, s[8:11], s42 offen sc1
  s_add_u32 s42, s42, 2359296
  buffer_load_dwordx4 v[36:39], v2, s[8:11], s42 offen sc1
  s_waitcnt vmcnt(8)
  s_lshl_b32 s43, s52, 16
  s_and_b32 s44, s52, 0xffff0000
  v_lshlrev_b32 v48, 16, v40
  v_and_b32 v49, 0xffff0000, v40
  v_add_f32 v48, s43, v48
  v_add_f32 v49, s44, v49
  s_lshl_b32 s43, s53, 16
  s_and_b32 s44, s53, 0xffff0000
  v_lshlrev_b32 v50, 16, v41
  v_and_b32 v51, 0xffff0000, v41
  v_add_f32 v50, s43, v50
  v_add_f32 v51, s44, v51
  s_lshl_b32 s43, s54, 16
  s_and_b32 s44, s54, 0xffff0000
  v_lshlrev_b32 v52, 16, v42
  v_and_b32 v53, 0xffff0000, v42
  v_add_f32 v52, s43, v52
  v_add_f32 v53, s44, v53
  s_lshl_b32 s43, s55, 16
  s_and_b32 s44, s55, 0xffff0000
  v_lshlrev_b32 v54, 16, v43
  v_and_b32 v55, 0xffff0000, v43
  v_add_f32 v54, s43, v54
  v_add_f32 v55, s44, v55
  s_waitcnt vmcnt(7)
  v_lshlrev_b32 v5, 16, v8
  v_and_b32 v6, 0xffff0000, v8
  v_add_f32 v48, v48, v5
  v_add_f32 v49, v49, v6
  v_lshlrev_b32 v5, 16, v9
  v_and_b32 v6, 0xffff0000, v9
  v_add_f32 v50, v50, v5
  v_add_f32 v51, v51, v6
  v_lshlrev_b32 v5, 16, v10
  v_and_b32 v6, 0xffff0000, v10
  v_add_f32 v52, v52, v5
  v_add_f32 v53, v53, v6
  v_lshlrev_b32 v5, 16, v11
  v_and_b32 v6, 0xffff0000, v11
  v_add_f32 v54, v54, v5
  v_add_f32 v55, v55, v6
  s_waitcnt vmcnt(6)
  v_lshlrev_b32 v5, 16, v12
  v_and_b32 v6, 0xffff0000, v12
  v_add_f32 v48, v48, v5
  v_add_f32 v49, v49, v6
  v_lshlrev_b32 v5, 16, v13
  v_and_b32 v6, 0xffff0000, v13
  v_add_f32 v50, v50, v5
  v_add_f32 v51, v51, v6
  v_lshlrev_b32 v5, 16, v14
  v_and_b32 v6, 0xffff0000, v14
  v_add_f32 v52, v52, v5
  v_add_f32 v53, v53, v6
  v_lshlrev_b32 v5, 16, v15
  v_and_b32 v6, 0xffff0000, v15
  v_add_f32 v54, v54, v5
  v_add_f32 v55, v55, v6
  s_waitcnt vmcnt(5)
  v_lshlrev_b32 v5, 16, v16
  v_and_b32 v6, 0xffff0000, v16
  v_add_f32 v48, v48, v5
  v_add_f32 v49, v49, v6
  v_lshlrev_b32 v5, 16, v17
  v_and_b32 v6, 0xffff0000, v17
  v_add_f32 v50, v50, v5
  v_add_f32 v51, v51, v6
  v_lshlrev_b32 v5, 16, v18
  v_and_b32 v6, 0xffff0000, v18
  v_add_f32 v52, v52, v5
  v_add_f32 v53, v53, v6
  v_lshlrev_b32 v5, 16, v19
  v_and_b32 v6, 0xffff0000, v19
  v_add_f32 v54, v54, v5
  v_add_f32 v55, v55, v6
  s_waitcnt vmcnt(4)
  v_lshlrev_b32 v5, 16, v20
  v_and_b32 v6, 0xffff0000, v20
  v_add_f32 v48, v48, v5
  v_add_f32 v49, v49, v6
  v_lshlrev_b32 v5, 16, v21
  v_and_b32 v6, 0xffff0000, v21
  v_add_f32 v50, v50, v5
  v_add_f32 v51, v51, v6
  v_lshlrev_b32 v5, 16, v22
  v_and_b32 v6, 0xffff0000, v22
  v_add_f32 v52, v52, v5
  v_add_f32 v53, v53, v6
  v_lshlrev_b32 v5, 16, v23
  v_and_b32 v6, 0xffff0000, v23
  v_add_f32 v54, v54, v5
  v_add_f32 v55, v55, v6
  s_waitcnt vmcnt(3)
  v_lshlrev_b32 v5, 16, v24
  v_and_b32 v6, 0xffff0000, v24
  v_add_f32 v48, v48, v5
  v_add_f32 v49, v49, v6
  v_lshlrev_b32 v5, 16, v25
  v_and_b32 v6, 0xffff0000, v25
  v_add_f32 v50, v50, v5
  v_add_f32 v51, v51, v6
  v_lshlrev_b32 v5, 16, v26
  v_and_b32 v6, 0xffff0000, v26
  v_add_f32 v52, v52, v5
  v_add_f32 v53, v53, v6
  v_lshlrev_b32 v5, 16, v27
  v_and_b32 v6, 0xffff0000, v27
  v_add_f32 v54, v54, v5
  v_add_f32 v55, v55, v6
  s_waitcnt vmcnt(2)
  v_lshlrev_b32 v5, 16, v28
  v_and_b32 v6, 0xffff0000, v28
  v_add_f32 v48, v48, v5
  v_add_f32 v49, v49, v6
  v_lshlrev_b32 v5, 16, v29
  v_and_b32 v6, 0xffff0000, v29
  v_add_f32 v50, v50, v5
  v_add_f32 v51, v51, v6
  v_lshlrev_b32 v5, 16, v30
  v_and_b32 v6, 0xffff0000, v30
  v_add_f32 v52, v52, v5
  v_add_f32 v53, v53, v6
  v_lshlrev_b32 v5, 16, v31
  v_and_b32 v6, 0xffff0000, v31
  v_add_f32 v54, v54, v5
  v_add_f32 v55, v55, v6
  s_waitcnt vmcnt(1)
  v_lshlrev_b32 v5, 16, v32
  v_and_b32 v6, 0xffff0000, v32
  v_add_f32 v48, v48, v5
  v_add_f32 v49, v49, v6
  v_lshlrev_b32 v5, 16, v33
  v_and_b32 v6, 0xffff0000, v33
  v_add_f32 v50, v50, v5
  v_add_f32 v51, v51, v6
  v_lshlrev_b32 v5, 16, v34
  v_and_b32 v6, 0xffff0000, v34
  v_add_f32 v52, v52, v5
  v_add_f32 v53, v53, v6
  v_lshlrev_b32 v5, 16, v35
  v_and_b32 v6, 0xffff0000, v35
  v_add_f32 v54, v54, v5
  v_add_f32 v55, v55, v6
  s_waitcnt vmcnt(0)
  v_lshlrev_b32 v5, 16, v36
  v_and_b32 v6, 0xffff0000, v36
  v_add_f32 v48, v48, v5
  v_add_f32 v49, v49, v6
  v_lshlrev_b32 v5, 16, v37
  v_and_b32 v6, 0xffff0000, v37
  v_add_f32 v50, v50, v5
  v_add_f32 v51, v51, v6
  v_lshlrev_b32 v5, 16, v38
  v_and_b32 v6, 0xffff0000, v38
  v_add_f32 v52, v52, v5
  v_add_f32 v53, v53, v6
  v_lshlrev_b32 v5, 16, v39
  v_and_b32 v6, 0xffff0000, v39
  v_add_f32 v54, v54, v5
  v_add_f32 v55, v55, v6
  v_cvt_pk_bf16_f32 v8, v48, v49
  v_cvt_pk_bf16_f32 v9, v50, v51
  v_cvt_pk_bf16_f32 v10, v52, v53
  v_cvt_pk_bf16_f32 v11, v54, v55
  s_cmp_lg_u32 s22, 0
  s_cbranch_scc1 L_D_final
  s_add_u32 s42, s41, 0x1800000
  buffer_store_dwordx4 v[8:11], v2, s[8:11], s42 offen sc1
  s_add_u32 s36, s27, 44
  s_lshl_b32 s37, s29, 10
  s_lshl_b32 s38, s30, 7
  s_add_u32 s37, s37, s38
  s_add_u32 s37, s37, s28
  s_add_u32 s37, s37, 163840
  s_lshl_b32 s38, s60, 2
  s_add_u32 s36, s36, s38
  s_lshl_b32 s38, s60, 15
  s_add_u32 s37, s37, s38
  s_waitcnt vmcnt(0)
  v_mov_b32 v14, s36
  v_mov_b32 v15, 1
  s_mov_b64 exec, 1
  ds_add_rtn_u32 v14, v14, v15
  s_waitcnt lgkmcnt(0)
  v_readfirstlane_b32 s36, v14
  v_mov_b32 v14, s62
  v_mov_b32 v15, s63
  v_lshlrev_b32 v16, 13, v1
  s_nop 0
  s_cmp_lg_u32 s36, 2
  s_cbranch_scc1 L_pub_54
  buffer_store_dwordx2 v[14:15], v16, s[8:11], s37 offen sc1
L_pub_54:
  s_mov_b64 exec, -1
  s_add_u32 s36, s27, 80
  s_lshl_b32 s37, s60, 2
  s_add_u32 s36, s36, s37
  v_mov_b32 v8, s36
L_lw_55:
  ds_read_b32 v9, v8
  s_waitcnt lgkmcnt(0)
  v_readfirstlane_b32 s36, v9
  s_nop 3
  s_cmp_ge_u32 s36, 1
  s_cbranch_scc1 L_lw_55_ok
  s_sleep 2
  s_branch L_lw_55
L_lw_55_ok:
  s_branch L_D_idle
L_D_final:
  s_movk_i32 s42, 1152
  v_mul_u32_u24 v5, s42, v1
  s_add_u32 s42, s39, s40
  buffer_store_dwordx4 v[8:11], v5, s[16:19], s42 offen
L_D_idle:
  s_cmp_lg_u32 s22, 0
  s_cbranch_scc1 L_interleave_layers__sliding_local_dilated__dense_activation_gelu__prompt_kernel_end
  s_mov_b32 s22, 1
  s_cmp_lt_u32 s60, 0
  s_cselect_b32 s57, 1, 0
  s_mov_b32 s23, 0x1800000
  s_mov_b32 s24, 0x1c00000
  s_mov_b32 s25, 0x2000000
  s_mov_b32 s26, 0x3800000
  s_mov_b32 s28, 0xf40000
  s_mov_b32 s27, 163456
  s_branch L_layer
L_interleave_layers__sliding_local_dilated__dense_activation_gelu__prompt_kernel_end:
L_interleave_layers__sliding_local_dilated__dense_activation_gelu__prompt_kernel_exit:
  s_endpgm
.section .rodata,"a"
.p2align 6
.amdhsa_kernel interleave_layers__sliding_local_dilated__dense_activation_gelu__prompt_kernel
  .amdhsa_next_free_vgpr 168
  .amdhsa_next_free_sgpr 96
  .amdhsa_accum_offset 168
  .amdhsa_group_segment_fixed_size 0
  .amdhsa_kernarg_size 88
  .amdhsa_user_sgpr_count 2
  .amdhsa_user_sgpr_kernarg_segment_ptr 1
  .amdhsa_system_sgpr_workgroup_id_x 1
  .amdhsa_float_denorm_mode_32 3
.end_amdhsa_kernel
.text
```
